```python
import torch

def _softmax(x, axis=-1):
    return torch.softmax(x, dim=axis)
def _gelu(x):
    return torch.nn.functional.gelu(x, approximate="tanh")
def _silu(x):
    return torch.nn.functional.silu(x)
def _sigmoid(x):
    return torch.sigmoid(x)
def _layernorm(x, axis=-1, eps=1e-5):
    m = x.mean(dim=axis, keepdim=True)
    v = x.var(dim=axis, keepdim=True, unbiased=False)
    return (x - m) / torch.sqrt(v + eps)
def _scatter_add(tgt, idx, src, axis=0):
    return tgt.clone().index_add_(axis, idx, src)
def _segment_sum(src, seg, n):
    out = torch.zeros((n,) + src.shape[1:], dtype=src.dtype)
    return out.index_add_(0, seg, src)
def _pad(x, pw):
    flat = tuple(v for pair in reversed(pw) for v in pair)
    return torch.nn.functional.pad(x, flat)

kernel_name = 'parallel_sum__sliding_block_cached__dense_activation_mish__decode'

def setup_inputs():

    _w = (lambda a: (lambda t: t.to(torch.bfloat16) if t.is_floating_point() else t)(torch.as_tensor(a)))
    def _A_setup():
        B, Sq, D = 4, 1, 448
        Hq, Hkv, Sk, Dh = 16, 8, 4096, 256
        assert Hq % Hkv == 0, (Hq, Hkv)
        return {
            "x": _w((lambda *s: torch.randn(*s, dtype=torch.bfloat16) * 0.05)(B, Sq, D)),
            "k_cache": _w((lambda *s: torch.randn(*s, dtype=torch.bfloat16) * 1.6)(B, Hkv, Sk, Dh)),
            "v_cache": _w((lambda *s: torch.randn(*s, dtype=torch.bfloat16) * 0.4)(B, Hkv, Sk, Dh)),
            "wq": _w((lambda *s: torch.randn(*s, dtype=torch.bfloat16) * 1.6)(D, Hq * Dh) * (D ** -0.5)),
            "wo": _w((lambda *s: torch.randn(*s, dtype=torch.bfloat16) * 0.4)(Hq * Dh, D) * ((Hq * Dh) ** -0.5)),
        }
    _A_in = _A_setup()

    def _B_setup():
        B, S, D, F = 4, 1, 448, 1792
        return {
            "x": _w((lambda *s: torch.randn(*s, dtype=torch.bfloat16) * 0.05)(B, S, D)),
            "w1": _w((lambda *s: torch.randn(*s, dtype=torch.bfloat16) * 0.8)(D, F) * (D ** -0.5)),
            "b1": _w((lambda *s: torch.randn(*s, dtype=torch.bfloat16) * 0.2)(F)),
            "w2": _w((lambda *s: torch.randn(*s, dtype=torch.bfloat16) * 0.1)(F, D) * (F ** -0.5)),
        }
    _B_in = _B_setup()

    return {
        "A_x": _A_in["x"],
        "A_k_cache": _A_in["k_cache"],
        "A_v_cache": _A_in["v_cache"],
        "A_wq": _A_in["wq"],
        "A_wo": _A_in["wo"],
        "B_x": _B_in["x"],
        "B_w1": _B_in["w1"],
        "B_b1": _B_in["b1"],
        "B_w2": _B_in["w2"],
    }

def reference(A_x, A_k_cache, A_v_cache, A_wq, A_wo, B_x, B_w1, B_b1, B_w2):
    def _A_ref(x, k_cache, v_cache, wq, wo):
        B, Sq, D = x.shape
        Hq, Dh = 16, 256
        Hkv, Sk = k_cache.shape[1], k_cache.shape[2]
        W = min(4096, max(256, Sk // 4))
        rep = Hq // Hkv
        q = (lambda x, *d: x.permute(*d))((x @ wq).reshape(B, Sq, Hq, Dh), 0, 2, 1, 3)
        k = (lambda x, n, axis: torch.repeat_interleave(x, n, dim=axis))(k_cache[:, :, Sk - W:, :], rep, axis=1)
        v = (lambda x, n, axis: torch.repeat_interleave(x, n, dim=axis))(v_cache[:, :, Sk - W:, :], rep, axis=1)
        scores = torch.einsum("bhqd,bhkd->bhqk", q, k) * (Dh ** -0.5)
        p = _softmax(scores, axis=-1)
        o = torch.einsum("bhqk,bhkd->bhqd", p, v)
        return (lambda x, *d: x.permute(*d))(o, 0, 2, 1, 3).reshape(B, Sq, Hq * Dh) @ wo

    def _B_ref(x, w1, b1, w2):
        h = torch.einsum("bsd,df->bsf", x, w1) + b1
        sp = torch.log1p(torch.exp(-torch.abs(h))) + torch.where(h > 0, h, torch.zeros_like(h))
        act = h * torch.tanh(sp)
        return torch.einsum("bsf,fd->bsd", act, w2)

    x = A_x
    xn = _layernorm(x, axis=-1)
    return x + _A_ref(xn, A_k_cache, A_v_cache, A_wq, A_wo) + _B_ref(xn, B_w1, B_b1, B_w2)
```

```asm
; @launch grid=(256,1,1) block=(512,1,1) lds=98304
.amdgcn_target "amdgcn-amd-amdhsa--gfx950"
.text
.globl parallel_sum__sliding_block_cached__dense_activation_mish__decode_kernel
.p2align 8
.type parallel_sum__sliding_block_cached__dense_activation_mish__decode_kernel,@function
parallel_sum__sliding_block_cached__dense_activation_mish__decode_kernel:
    s_cmp_ge_u32 s2, 256
    s_cbranch_scc1 EXIT
    s_load_dwordx16 s[64:79], s[0:1], 0
    s_load_dwordx8 s[80:87], s[0:1], 64
    s_getpc_b64 s[36:37]
    v_lshrrev_b32 v1, 6, v0
    s_lshr_b32 s38, s2, 3
    s_mul_i32 s39, s38, 26
    s_lshr_b32 s39, s39, 8
    s_mul_i32 s39, s39, 10
    s_sub_u32 s38, s38, s39
    s_lshl_b32 s38, s38, 10
    v_lshl_add_u32 v2, v1, 7, s38
    global_load_dword v215, v2, s[36:37]
    v_and_b32 v0, 63, v0
    v_readfirstlane_b32 s3, v1
    s_and_b32 s28, s2, 7
    s_lshr_b32 s29, s2, 3
    s_lshr_b32 s30, s2, 6
    s_bfe_u32 s31, s2, 0x30003
    s_getreg_b32 s34, hwreg(HW_REG_XCC_ID, 0, 4)
    s_mov_b32 s33, 1000000
    s_mov_b32 s6, 0xe00
    s_mov_b32 s7, 0x20000
    s_mov_b32 s10, 0x4000000
    s_mov_b32 s11, 0x20000
    s_mov_b32 s14, 0x380000
    s_mov_b32 s15, 0x20000
    s_mov_b32 s18, 0x188000
    s_mov_b32 s19, 0x20000
    s_mov_b32 s22, 0x10000000
    s_mov_b32 s23, 0x20000
    s_mov_b32 s26, 0xe00
    s_mov_b32 s27, 0x20000
    s_lshl_b32 s36, s30, 3
    s_add_u32 s36, s36, s28
    s_lshl_b32 s36, s36, 21
    s_lshl_b32 s38, s31, 12
    s_lshl_b32 s93, s28, 1
    s_mul_i32 s37, s30, 5
    s_add_u32 s93, s93, s37
    s_lshl_b32 s93, s93, 15
    s_and_b32 s93, s93, 0x78000
    s_add_u32 s36, s36, 1572864
    v_lshrrev_b32 v4, 4, v0
    v_and_b32 v5, 3, v0
    v_bfe_u32 v3, v0, 2, 2
    v_lshrrev_b32 v11, 3, v0
    v_lshlrev_b32 v10, 1, v4
    v_xor_b32 v10, v10, v0
    v_and_b32 v10, 7, v10
    v_lshlrev_b32 v10, 4, v10
    s_lshl_b32 s39, s28, 5
    s_add_u32 s39, s39, s29
    s_mov_b32 s101, s93
    s_cmp_lg_u32 s3, 0
    s_cbranch_scc1 NOTW0
    s_setprio 3
    s_mul_i32 s98, s30, 917504
    s_lshl_b32 s97, s28, 10
    s_add_u32 s98, s98, s97
    s_lshl_b32 s97, s31, 7
    s_add_u32 s98, s98, s97
    s_mul_i32 s99, s30, 401408
    s_mul_i32 s97, s28, 448
    s_add_u32 s99, s99, s97
    s_lshl_b32 s97, s31, 6
    s_add_u32 s99, s99, s97
    s_cmp_eq_u32 s31, 7
    s_cselect_b32 s99, 0x40000000, s99
    v_mul_u32_u24 v6, 896, v3
    v_lshl_add_u32 v7, v4, 2, v5
    v_lshl_add_u32 v8, v4, 3, v6
    v_lshl_add_u32 v1, v7, 3, v6
    v_lshl_add_u32 v6, v7, 4, v6
    v_lshl_add_u32 v9, v11, 13, v10
    v_lshrrev_b32 v2, 2, v0
    v_mul_u32_u24 v2, 3584, v2
    v_and_b32 v7, 48, v10
    v_add_u32 v2, v2, v7
    s_mul_i32 s37, s30, 224
    s_mov_b32 m0, 0
    v_mov_b32 v20, -1
    v_mov_b32 v21, -1
    v_mov_b32 v22, -1
    v_mov_b32 v23, -1
    v_lshlrev_b32 v24, 4, v0
    s_lshl_b32 s96, s39, 10
    s_add_u32 s96, s96, 0xd0000
    v_mov_b32 v16, 0
    v_mov_b32 v17, 0
    ds_write_b64 v16, v[16:17] offset:59392
    ds_write_b64 v16, v[16:17] offset:59400
    s_waitcnt lgkmcnt(0)
    s_mov_b64 s[12:13], s[70:71]
    s_mov_b64 s[4:5], s[64:65]
    s_mov_b64 s[16:17], s[76:77]
    s_mov_b64 s[20:21], s[86:87]
    buffer_load_dwordx4 v9, s[12:15], s98 offen nt lds
    s_add_u32 m0, m0, 1024
    s_add_u32 s98, s98, 65536
    buffer_load_dwordx4 v9, s[12:15], s98 offen nt lds
    buffer_store_dwordx4 v[20:23], v24, s[20:23], s96 offen
    buffer_load_dwordx4 v[84:87], v6, s[4:7], 0 offen offset:0
    buffer_load_dwordx4 v[88:91], v6, s[4:7], 0 offen offset:256
    buffer_load_dwordx4 v[92:95], v6, s[4:7], 0 offen offset:512
    buffer_load_dwordx2 v[96:97], v1, s[4:7], 0 offen offset:768
    buffer_load_dwordx2 v[100:101], v8, s[4:7], s37 offen offset:0
    buffer_load_dwordx2 v[102:103], v8, s[4:7], s37 offen offset:32
    buffer_load_dwordx2 v[104:105], v8, s[4:7], s37 offen offset:64
    buffer_load_dwordx2 v[106:107], v8, s[4:7], s37 offen offset:96
    buffer_load_dwordx2 v[108:109], v8, s[4:7], s37 offen offset:128
    buffer_load_dwordx2 v[110:111], v8, s[4:7], s37 offen offset:160
    buffer_load_dwordx2 v[112:113], v8, s[4:7], s37 offen offset:192
    s_add_u32 m0, m0, 1024
    s_add_u32 s98, s98, 65536
    buffer_load_dwordx4 v9, s[12:15], s98 offen nt lds
    s_add_u32 m0, m0, 1024
    s_add_u32 s98, s98, 65536
    buffer_load_dwordx4 v9, s[12:15], s98 offen nt lds
    s_add_u32 m0, m0, 1024
    s_add_u32 s98, s98, 65536
    buffer_load_dwordx4 v9, s[12:15], s98 offen nt lds
    s_add_u32 m0, m0, 1024
    s_add_u32 s98, s98, 65536
    buffer_load_dwordx4 v9, s[12:15], s98 offen nt lds
    s_add_u32 m0, m0, 1024
    s_add_u32 s98, s98, 65536
    buffer_load_dwordx4 v9, s[12:15], s98 offen nt lds
    s_add_u32 m0, m0, 1024
    s_add_u32 s98, s98, 65536
    buffer_load_dwordx4 v9, s[12:15], s98 offen nt lds
    s_add_u32 m0, m0, 1024
    s_add_u32 s98, s98, 65536
    buffer_load_dwordx4 v9, s[12:15], s98 offen nt lds
    s_add_u32 m0, m0, 1024
    s_add_u32 s98, s98, 65536
    buffer_load_dwordx4 v9, s[12:15], s98 offen nt lds
    s_add_u32 m0, m0, 1024
    s_add_u32 s98, s98, 65536
    buffer_load_dwordx4 v9, s[12:15], s98 offen nt lds
    s_add_u32 m0, m0, 1024
    s_add_u32 s98, s98, 65536
    buffer_load_dwordx4 v9, s[12:15], s98 offen nt lds
    s_add_u32 m0, m0, 1024
    s_add_u32 s98, s98, 65536
    buffer_load_dwordx4 v9, s[12:15], s98 offen nt lds
    s_add_u32 m0, m0, 1024
    s_add_u32 s98, s98, 65536
    buffer_load_dwordx4 v9, s[12:15], s98 offen nt lds
    s_add_u32 m0, m0, 1024
    s_nop 0
    buffer_load_dwordx4 v2, s[16:19], s99 offen nt lds
    s_add_u32 m0, m0, 1024
    s_add_u32 s99, s99, 57344
    buffer_load_dwordx4 v2, s[16:19], s99 offen nt lds
    s_add_u32 m0, m0, 1024
    s_add_u32 s99, s99, 57344
    buffer_load_dwordx4 v2, s[16:19], s99 offen nt lds
    s_add_u32 m0, m0, 1024
    s_add_u32 s99, s99, 57344
    buffer_load_dwordx4 v2, s[16:19], s99 offen nt lds
    s_add_u32 m0, m0, 1024
    s_add_u32 s99, s99, 57344
    buffer_load_dwordx4 v2, s[16:19], s99 offen nt lds
    s_add_u32 m0, m0, 1024
    s_add_u32 s99, s99, 57344
    buffer_load_dwordx4 v2, s[16:19], s99 offen nt lds
    s_add_u32 m0, m0, 1024
    s_add_u32 s99, s99, 57344
    buffer_load_dwordx4 v2, s[16:19], s99 offen nt lds
    s_load_dword s32, s[86:87], 0
    s_mov_b64 s[8:9], s[68:69]
    s_branch V_PROJ
NOTW0:
    s_cmp_ge_u32 s3, 4
    s_waitcnt lgkmcnt(0)
    s_load_dword s32, s[86:87], 0
    s_mov_b64 s[20:21], s[86:87]
    s_cselect_b64 s[8:9], s[66:67], s[68:69]
    s_cbranch_scc1 KWAVE
    s_barrier
    s_waitcnt lgkmcnt(0)
    s_mul_i32 s32, s32, 1664525
    s_add_u32 s32, s32, 1013904223
    s_branch V_B2
KWAVE:
    s_sub_u32 s3, s3, 4
    s_setprio 2
    v_lshlrev_b32 v1, 9, v3
    v_lshl_add_u32 v1, v4, 6, v1
    v_lshl_add_u32 v1, v5, 4, v1
    s_lshr_b32 s37, s3, 1
    s_lshl_b32 s94, s37, 14
    s_xor_b32 s38, s38, s94
    s_lshl_b32 s37, s37, 18
    s_xor_b32 s93, s93, s37
    s_and_b32 s37, s3, 1
    s_lshl_b32 s37, s37, 11
    s_add_u32 s36, s36, s37
    s_barrier
    s_or_b32 s37, s93, s38
    s_add_u32 s37, s36, s37
    buffer_load_dwordx4 v[16:19], v1, s[8:11], s37 offen offset:0 nt
    buffer_load_dwordx4 v[20:23], v1, s[8:11], s37 offen offset:256 nt
    s_add_u32 s93, s93, 32768
    s_and_b32 s93, s93, 0x78000
    s_add_u32 s38, s38, 4096
    s_and_b32 s38, s38, 0x7000
    s_or_b32 s37, s93, s38
    s_add_u32 s37, s36, s37
    buffer_load_dwordx4 v[24:27], v1, s[8:11], s37 offen offset:0 nt
    buffer_load_dwordx4 v[28:31], v1, s[8:11], s37 offen offset:256 nt
    s_add_u32 s93, s93, 32768
    s_and_b32 s93, s93, 0x78000
    s_add_u32 s38, s38, 4096
    s_and_b32 s38, s38, 0x7000
    s_or_b32 s37, s93, s38
    s_add_u32 s37, s36, s37
    buffer_load_dwordx4 v[32:35], v1, s[8:11], s37 offen offset:0 nt
    buffer_load_dwordx4 v[36:39], v1, s[8:11], s37 offen offset:256 nt
    s_add_u32 s93, s93, 32768
    s_and_b32 s93, s93, 0x78000
    s_add_u32 s38, s38, 4096
    s_and_b32 s38, s38, 0x7000
    s_branch K_MAIN
V_PROJ:
    v_lshrrev_b32 v12, 2, v0
    v_lshlrev_b32 v12, 7, v12
    v_lshl_add_u32 v12, v5, 3, v12
    v_and_b32 v13, 3, v11
    v_lshl_add_u32 v12, v13, 5, v12
    v_xor_b32 v13, 32, v12
    v_xor_b32 v14, 64, v12
    v_xor_b32 v15, 96, v12
    s_mov_b32 s37, 0x3f803f80
    v_mov_b32 v6, 0
    v_mov_b32 v7, 0
    v_mov_b32 v114, 0
    v_mov_b32 v115, 0
    v_mov_b32 v130, 0
    v_mov_b32 v131, 0
    v_mov_b32 v146, 0
    v_mov_b32 v147, 0
    v_mov_b32 v162, 0
    v_mov_b32 v163, 0
    v_mov_b32 v178, 0
    v_mov_b32 v179, 0
    s_mov_b32 s88, 0x22222222
    s_mov_b32 s89, 0x22222222
    s_mov_b32 s90, 0x44444444
    s_mov_b32 s91, 0x44444444
    s_mov_b32 s92, 0x88888888
    s_mov_b32 s93, 0x88888888
    v_lshlrev_b32 v2, 6, v4
    v_lshl_add_u32 v2, v5, 4, v2
    v_lshl_add_u32 v1, v3, 9, v2
    v_lshl_add_u32 v2, v3, 8, v2
    v_lshrrev_b32 v80, 2, v0
    v_lshlrev_b32 v80, 6, v80
    v_lshl_add_u32 v80, v5, 3, v80
    v_and_b32 v81, 1, v4
    v_lshl_add_u32 v80, v81, 5, v80
    v_xor_b32 v81, 32, v80
    s_lshl_b32 s98, s39, 10
    s_add_u32 s98, s98, 0x8000
    s_lshl_b32 s99, s28, 1
    s_lshr_b32 s94, s30, 1
    s_add_u32 s99, s99, s94
    s_lshl_b32 s99, s99, 3
    s_add_u32 s99, s99, s31
    s_lshl_b32 s99, s99, 10
    s_add_u32 s99, s99, 0x88000
    s_and_b32 s94, s30, 1
    s_lshl_b32 s94, s94, 5
    s_add_u32 s99, s99, s94
    s_mov_b32 s94, 0x7060500
    s_mov_b32 s95, 0x7060501
    s_mov_b32 s96, 0x7060502
    s_mov_b32 s97, 0x7060503
    s_barrier
    s_waitcnt vmcnt(26)
    v_dot2c_f32_bf16 v6, s37, v84
    v_dot2c_f32_bf16 v7, v84, v84
    v_dot2c_f32_bf16 v6, s37, v85
    v_dot2c_f32_bf16 v7, v85, v85
    v_dot2c_f32_bf16 v6, s37, v86
    v_dot2c_f32_bf16 v7, v86, v86
    v_dot2c_f32_bf16 v6, s37, v87
    v_dot2c_f32_bf16 v7, v87, v87
    v_dot2c_f32_bf16 v6, s37, v88
    v_dot2c_f32_bf16 v7, v88, v88
    v_dot2c_f32_bf16 v6, s37, v89
    v_dot2c_f32_bf16 v7, v89, v89
    v_dot2c_f32_bf16 v6, s37, v90
    v_dot2c_f32_bf16 v7, v90, v90
    v_dot2c_f32_bf16 v6, s37, v91
    v_dot2c_f32_bf16 v7, v91, v91
    v_dot2c_f32_bf16 v6, s37, v92
    v_dot2c_f32_bf16 v7, v92, v92
    v_dot2c_f32_bf16 v6, s37, v93
    v_dot2c_f32_bf16 v7, v93, v93
    v_dot2c_f32_bf16 v6, s37, v94
    v_dot2c_f32_bf16 v7, v94, v94
    v_dot2c_f32_bf16 v6, s37, v95
    v_dot2c_f32_bf16 v7, v95, v95
    v_dot2c_f32_bf16 v6, s37, v96
    v_dot2c_f32_bf16 v7, v96, v96
    v_dot2c_f32_bf16 v6, s37, v97
    v_dot2c_f32_bf16 v7, v97, v97
    s_nop 1
    v_add_f32_dpp v6, v6, v6 quad_perm:[1,0,3,2] row_mask:0xf bank_mask:0xf
    v_add_f32_dpp v7, v7, v7 quad_perm:[1,0,3,2] row_mask:0xf bank_mask:0xf
    s_nop 0
    v_add_f32_dpp v6, v6, v6 quad_perm:[2,3,0,1] row_mask:0xf bank_mask:0xf
    v_add_f32_dpp v7, v7, v7 quad_perm:[2,3,0,1] row_mask:0xf bank_mask:0xf
    v_mov_b32 v8, v6
    v_mov_b32 v9, v7
    s_nop 0
    v_permlane16_swap_b32 v6, v8
    v_permlane16_swap_b32 v7, v9
    v_add_f32 v6, v6, v8
    v_add_f32 v7, v7, v9
    v_mov_b32 v8, v6
    v_mov_b32 v9, v7
    s_nop 0
    v_permlane32_swap_b32 v6, v8
    v_permlane32_swap_b32 v7, v9
    v_add_f32 v6, v6, v8
    v_add_f32 v7, v7, v9
    v_mul_f32 v6, 0x3b124925, v6
    v_mul_f32 v7, 0x3b124925, v7
    v_fma_f32 v7, -v6, v6, v7
    v_max_f32 v7, 0, v7
    v_cvt_pk_bf16_f32 v7, v7, v7
    v_lshlrev_b32 v7, 16, v7
    v_add_f32 v7, 0x3727c5ac, v7
    v_cvt_pk_bf16_f32 v7, v7, v7
    v_lshlrev_b32 v7, 16, v7
    v_sqrt_f32 v7, v7
    v_cvt_pk_bf16_f32 v6, v6, v6
    v_lshlrev_b32 v6, 16, v6
    v_cvt_pk_bf16_f32 v7, v7, v7
    v_lshlrev_b32 v7, 16, v7
    v_rcp_f32 v7, v7
    s_waitcnt vmcnt(19)
    v_mul_f32 v6, v6, v7
    v_lshlrev_b32 v84, 16, v100
    v_and_b32 v85, 0xffff0000, v100
    v_fma_f32 v84, v84, v7, -v6
    v_fma_f32 v85, v85, v7, -v6
    v_cvt_pk_bf16_f32 v100, v84, v85
    v_lshlrev_b32 v86, 16, v101
    v_and_b32 v87, 0xffff0000, v101
    v_fma_f32 v86, v86, v7, -v6
    v_fma_f32 v87, v87, v7, -v6
    v_cvt_pk_bf16_f32 v101, v86, v87
    v_lshlrev_b32 v84, 16, v102
    v_and_b32 v85, 0xffff0000, v102
    v_fma_f32 v84, v84, v7, -v6
    v_fma_f32 v85, v85, v7, -v6
    v_cvt_pk_bf16_f32 v102, v84, v85
    v_lshlrev_b32 v86, 16, v103
    v_and_b32 v87, 0xffff0000, v103
    v_fma_f32 v86, v86, v7, -v6
    v_fma_f32 v87, v87, v7, -v6
    v_cvt_pk_bf16_f32 v103, v86, v87
    v_lshlrev_b32 v84, 16, v104
    v_and_b32 v85, 0xffff0000, v104
    v_fma_f32 v84, v84, v7, -v6
    v_fma_f32 v85, v85, v7, -v6
    v_cvt_pk_bf16_f32 v104, v84, v85
    v_lshlrev_b32 v86, 16, v105
    v_and_b32 v87, 0xffff0000, v105
    v_fma_f32 v86, v86, v7, -v6
    v_fma_f32 v87, v87, v7, -v6
    v_cvt_pk_bf16_f32 v105, v86, v87
    v_lshlrev_b32 v84, 16, v106
    v_and_b32 v85, 0xffff0000, v106
    v_fma_f32 v84, v84, v7, -v6
    v_fma_f32 v85, v85, v7, -v6
    v_cvt_pk_bf16_f32 v106, v84, v85
    v_lshlrev_b32 v86, 16, v107
    v_and_b32 v87, 0xffff0000, v107
    v_fma_f32 v86, v86, v7, -v6
    v_fma_f32 v87, v87, v7, -v6
    v_cvt_pk_bf16_f32 v107, v86, v87
    v_lshlrev_b32 v84, 16, v108
    v_and_b32 v85, 0xffff0000, v108
    v_fma_f32 v84, v84, v7, -v6
    v_fma_f32 v85, v85, v7, -v6
    v_cvt_pk_bf16_f32 v108, v84, v85
    v_lshlrev_b32 v86, 16, v109
    v_and_b32 v87, 0xffff0000, v109
    v_fma_f32 v86, v86, v7, -v6
    v_fma_f32 v87, v87, v7, -v6
    v_cvt_pk_bf16_f32 v109, v86, v87
    v_lshlrev_b32 v84, 16, v110
    v_and_b32 v85, 0xffff0000, v110
    v_fma_f32 v84, v84, v7, -v6
    v_fma_f32 v85, v85, v7, -v6
    v_cvt_pk_bf16_f32 v110, v84, v85
    v_lshlrev_b32 v86, 16, v111
    v_and_b32 v87, 0xffff0000, v111
    v_fma_f32 v86, v86, v7, -v6
    v_fma_f32 v87, v87, v7, -v6
    v_cvt_pk_bf16_f32 v111, v86, v87
    v_lshlrev_b32 v84, 16, v112
    v_and_b32 v85, 0xffff0000, v112
    v_fma_f32 v84, v84, v7, -v6
    v_fma_f32 v85, v85, v7, -v6
    v_cvt_pk_bf16_f32 v112, v84, v85
    v_lshlrev_b32 v86, 16, v113
    v_and_b32 v87, 0xffff0000, v113
    v_fma_f32 v86, v86, v7, -v6
    v_fma_f32 v87, v87, v7, -v6
    v_cvt_pk_bf16_f32 v113, v86, v87
    s_waitcnt lgkmcnt(0)
    s_mul_i32 s32, s32, 1664525
    s_add_u32 s32, s32, 1013904223
    s_xor_b32 s35, s32, s34
    v_mov_b32 v199, s35
    s_waitcnt vmcnt(7)
    ds_read_b64_tr_b16 v[116:117], v12 offset:0
    ds_read_b64_tr_b16 v[118:119], v12 offset:2048
    ds_read_b64_tr_b16 v[120:121], v12 offset:4096
    ds_read_b64_tr_b16 v[122:123], v12 offset:6144
    ds_read_b64_tr_b16 v[124:125], v12 offset:8192
    ds_read_b64_tr_b16 v[126:127], v12 offset:10240
    ds_read_b64_tr_b16 v[128:129], v12 offset:12288
    ds_read_b64_tr_b16 v[132:133], v13 offset:0
    ds_read_b64_tr_b16 v[134:135], v13 offset:2048
    ds_read_b64_tr_b16 v[136:137], v13 offset:4096
    ds_read_b64_tr_b16 v[138:139], v13 offset:6144
    ds_read_b64_tr_b16 v[140:141], v13 offset:8192
    ds_read_b64_tr_b16 v[142:143], v13 offset:10240
    ds_read_b64_tr_b16 v[144:145], v13 offset:12288
    s_waitcnt lgkmcnt(7)
    v_mfma_f32_16x16x32_bf16 v[180:183], v[116:119], v[100:103], 0
    v_mfma_f32_16x16x32_bf16 v[180:183], v[120:123], v[104:107], v[180:183]
    v_mfma_f32_16x16x32_bf16 v[180:183], v[124:127], v[108:111], v[180:183]
    v_mfma_f32_16x16x32_bf16 v[180:183], v[128:131], v[112:115], v[180:183]
    ds_read_b64_tr_b16 v[148:149], v14 offset:0
    ds_read_b64_tr_b16 v[150:151], v14 offset:2048
    ds_read_b64_tr_b16 v[152:153], v14 offset:4096
    ds_read_b64_tr_b16 v[154:155], v14 offset:6144
    ds_read_b64_tr_b16 v[156:157], v14 offset:8192
    ds_read_b64_tr_b16 v[158:159], v14 offset:10240
    ds_read_b64_tr_b16 v[160:161], v14 offset:12288
    s_waitcnt lgkmcnt(7)
    v_mfma_f32_16x16x32_bf16 v[184:187], v[132:135], v[100:103], 0
    v_mfma_f32_16x16x32_bf16 v[184:187], v[136:139], v[104:107], v[184:187]
    v_mfma_f32_16x16x32_bf16 v[184:187], v[140:143], v[108:111], v[184:187]
    v_mfma_f32_16x16x32_bf16 v[184:187], v[144:147], v[112:115], v[184:187]
    ds_read_b64_tr_b16 v[164:165], v15 offset:0
    ds_read_b64_tr_b16 v[166:167], v15 offset:2048
    ds_read_b64_tr_b16 v[168:169], v15 offset:4096
    ds_read_b64_tr_b16 v[170:171], v15 offset:6144
    ds_read_b64_tr_b16 v[172:173], v15 offset:8192
    ds_read_b64_tr_b16 v[174:175], v15 offset:10240
    ds_read_b64_tr_b16 v[176:177], v15 offset:12288
    s_waitcnt lgkmcnt(7)
    v_mfma_f32_16x16x32_bf16 v[188:191], v[148:151], v[100:103], 0
    v_mfma_f32_16x16x32_bf16 v[188:191], v[152:155], v[104:107], v[188:191]
    v_mfma_f32_16x16x32_bf16 v[188:191], v[156:159], v[108:111], v[188:191]
    v_mfma_f32_16x16x32_bf16 v[188:191], v[160:163], v[112:115], v[188:191]
    s_waitcnt lgkmcnt(0)
    v_mfma_f32_16x16x32_bf16 v[192:195], v[164:167], v[100:103], 0
    v_mfma_f32_16x16x32_bf16 v[192:195], v[168:171], v[104:107], v[192:195]
    v_mfma_f32_16x16x32_bf16 v[192:195], v[172:175], v[108:111], v[192:195]
    v_mfma_f32_16x16x32_bf16 v[192:195], v[176:179], v[112:115], v[192:195]
    v_cndmask_b32 v84, v180, v184, s[88:89]
    v_cndmask_b32 v85, v181, v185, s[88:89]
    v_cndmask_b32 v86, v182, v186, s[88:89]
    v_cndmask_b32 v87, v183, v187, s[88:89]
    v_cndmask_b32 v84, v84, v188, s[90:91]
    v_cndmask_b32 v85, v85, v189, s[90:91]
    v_cndmask_b32 v86, v86, v190, s[90:91]
    v_cndmask_b32 v87, v87, v191, s[90:91]
    v_cndmask_b32 v84, v84, v192, s[92:93]
    v_cndmask_b32 v85, v85, v193, s[92:93]
    v_cndmask_b32 v86, v86, v194, s[92:93]
    v_cndmask_b32 v87, v87, v195, s[92:93]
    v_perm_b32 v84, v84, v199, s94
    v_perm_b32 v85, v85, v199, s95
    v_perm_b32 v86, v86, v199, s96
    v_perm_b32 v87, v87, v199, s97
    buffer_store_dwordx4 v[84:87], v2, s[20:23], s98 offen
    s_waitcnt vmcnt(1)
    ds_read_b64_tr_b16 v[116:117], v80 offset:14336
    ds_read_b64_tr_b16 v[118:119], v80 offset:15360
    ds_read_b64_tr_b16 v[120:121], v80 offset:16384
    ds_read_b64_tr_b16 v[122:123], v80 offset:17408
    ds_read_b64_tr_b16 v[124:125], v80 offset:18432
    ds_read_b64_tr_b16 v[126:127], v80 offset:19456
    ds_read_b64_tr_b16 v[128:129], v80 offset:20480
    ds_read_b64_tr_b16 v[132:133], v81 offset:14336
    ds_read_b64_tr_b16 v[134:135], v81 offset:15360
    ds_read_b64_tr_b16 v[136:137], v81 offset:16384
    ds_read_b64_tr_b16 v[138:139], v81 offset:17408
    ds_read_b64_tr_b16 v[140:141], v81 offset:18432
    ds_read_b64_tr_b16 v[142:143], v81 offset:19456
    ds_read_b64_tr_b16 v[144:145], v81 offset:20480
    s_waitcnt lgkmcnt(7)
    v_mfma_f32_16x16x32_bf16 v[180:183], v[116:119], v[100:103], 0
    v_mfma_f32_16x16x32_bf16 v[180:183], v[120:123], v[104:107], v[180:183]
    v_mfma_f32_16x16x32_bf16 v[180:183], v[124:127], v[108:111], v[180:183]
    v_mfma_f32_16x16x32_bf16 v[180:183], v[128:131], v[112:115], v[180:183]
    s_waitcnt lgkmcnt(0)
    v_mfma_f32_16x16x32_bf16 v[184:187], v[132:135], v[100:103], 0
    v_mfma_f32_16x16x32_bf16 v[184:187], v[136:139], v[104:107], v[184:187]
    v_mfma_f32_16x16x32_bf16 v[184:187], v[140:143], v[108:111], v[184:187]
    v_mfma_f32_16x16x32_bf16 v[184:187], v[144:147], v[112:115], v[184:187]
    s_nop 7
    v_cndmask_b32 v88, v180, v184, s[88:89]
    v_cndmask_b32 v89, v181, v185, s[88:89]
    v_cndmask_b32 v90, v182, v186, s[88:89]
    v_cndmask_b32 v91, v183, v187, s[88:89]
    v_perm_b32 v88, v88, v199, s94
    v_perm_b32 v89, v89, v199, s95
    v_perm_b32 v90, v90, v199, s96
    v_perm_b32 v91, v91, v199, s97
    s_mov_b32 exec_lo, 0x33333333
    s_mov_b32 exec_hi, 0x33333333
    buffer_store_dwordx4 v[88:91], v2, s[20:23], s99 offen
    s_mov_b64 exec, -1
    s_setprio 0
V_B2:
    s_barrier
V_B2X:
    v_lshlrev_b32 v1, 9, v11
    v_and_b32 v6, 7, v0
    v_lshl_add_u32 v1, v6, 4, v1
    s_lshl_b32 s37, s3, 7
    s_add_u32 s36, s36, s37
    s_mov_b32 s98, 0x05040100
    s_mov_b32 s99, 0x07060302
    v_bfe_u32 v6, v0, 2, 1
    v_lshlrev_b32 v8, 9, v6
    v_lshl_add_u32 v8, v4, 6, v8
    v_and_b32 v7, 1, v0
    v_lshl_add_u32 v8, v7, 5, v8
    v_lshlrev_b32 v6, 9, v6
    s_lshl_b32 s95, s28, 10
    s_lshl_b32 s96, s29, 4
    s_add_u32 s95, s95, s96
    s_add_u32 s95, s95, 0x150000
    s_lshl_b32 s96, s28, 15
    s_lshl_b32 s97, s3, 12
    s_add_u32 s96, s96, s97
    s_lshr_b32 s97, s31, 2
    s_lshl_b32 s97, s97, 10
    s_add_u32 s96, s96, s97
    s_lshl_b32 s97, s30, 2
    s_and_b32 s94, s31, 3
    s_add_u32 s97, s97, s94
    s_lshl_b32 s97, s97, 4
    s_add_u32 s94, s96, s97
    s_add_u32 s94, s94, 0xd0000
    v_bfe_u32 v9, v0, 4, 1
    v_lshlrev_b32 v10, 14, v9
    v_bfe_u32 v7, v0, 2, 1
    v_lshl_add_u32 v10, v7, 11, v10
    v_lshl_add_u32 v7, v5, 8, v10
    v_mov_b32 v2, 0
    s_mov_b32 s100, 0x3db8aa3b
    s_or_b32 s37, s101, s38
    s_add_u32 s37, s36, s37
    buffer_load_dwordx4 v[16:19], v1, s[8:11], s37 offen nt
    s_add_u32 s101, s101, 32768
    s_and_b32 s101, s101, 0x78000
    s_add_u32 s38, s38, 4096
    s_and_b32 s38, s38, 0x7000
    s_or_b32 s37, s101, s38
    s_add_u32 s37, s36, s37
    buffer_load_dwordx4 v[20:23], v1, s[8:11], s37 offen nt
    s_add_u32 s101, s101, 32768
    s_and_b32 s101, s101, 0x78000
    s_add_u32 s38, s38, 4096
    s_and_b32 s38, s38, 0x7000
    s_barrier
V_NOB2C:
    s_or_b32 s37, s101, s38
    s_add_u32 s37, s36, s37
    buffer_load_dwordx4 v[24:27], v1, s[8:11], s37 offen nt
    s_add_u32 s101, s101, 32768
    s_and_b32 s101, s101, 0x78000
    s_add_u32 s38, s38, 4096
    s_and_b32 s38, s38, 0x7000
    s_or_b32 s37, s101, s38
    s_add_u32 s37, s36, s37
    buffer_load_dwordx4 v[28:31], v1, s[8:11], s37 offen nt
    s_add_u32 s101, s101, 32768
    s_and_b32 s101, s101, 0x78000
    s_add_u32 s38, s38, 4096
    s_and_b32 s38, s38, 0x7000
    s_or_b32 s37, s101, s38
    s_add_u32 s37, s36, s37
    buffer_load_dwordx4 v[32:35], v1, s[8:11], s37 offen nt
    s_add_u32 s101, s101, 32768
    s_and_b32 s101, s101, 0x78000
    s_add_u32 s38, s38, 4096
    s_and_b32 s38, s38, 0x7000
    s_or_b32 s37, s101, s38
    s_add_u32 s37, s36, s37
    buffer_load_dwordx4 v[36:39], v1, s[8:11], s37 offen nt
    s_add_u32 s101, s101, 32768
    s_and_b32 s101, s101, 0x78000
    s_add_u32 s38, s38, 4096
    s_and_b32 s38, s38, 0x7000
    s_or_b32 s37, s101, s38
    s_add_u32 s37, s36, s37
    buffer_load_dwordx4 v[40:43], v1, s[8:11], s37 offen nt
    s_add_u32 s101, s101, 32768
    s_and_b32 s101, s101, 0x78000
    s_add_u32 s38, s38, 4096
    s_and_b32 s38, s38, 0x7000
    s_or_b32 s37, s101, s38
    s_add_u32 s37, s36, s37
    buffer_load_dwordx4 v[44:47], v1, s[8:11], s37 offen nt
    s_add_u32 s101, s101, 32768
    s_and_b32 s101, s101, 0x78000
    s_add_u32 s38, s38, 20480
    s_and_b32 s38, s38, 0x7000
    s_or_b32 s37, s101, s38
    s_add_u32 s37, s36, s37
    buffer_load_dwordx4 v[48:51], v1, s[8:11], s37 offen nt
    s_add_u32 s101, s101, 32768
    s_and_b32 s101, s101, 0x78000
    s_add_u32 s38, s38, 4096
    s_and_b32 s38, s38, 0x7000
    s_or_b32 s37, s101, s38
    s_add_u32 s37, s36, s37
    buffer_load_dwordx4 v[52:55], v1, s[8:11], s37 offen nt
    s_add_u32 s101, s101, 32768
    s_and_b32 s101, s101, 0x78000
    s_add_u32 s38, s38, 4096
    s_and_b32 s38, s38, 0x7000
    s_or_b32 s37, s101, s38
    s_add_u32 s37, s36, s37
    buffer_load_dwordx4 v[56:59], v1, s[8:11], s37 offen nt
    s_add_u32 s101, s101, 32768
    s_and_b32 s101, s101, 0x78000
    s_add_u32 s38, s38, 4096
    s_and_b32 s38, s38, 0x7000
    s_or_b32 s37, s101, s38
    s_add_u32 s37, s36, s37
    buffer_load_dwordx4 v[60:63], v1, s[8:11], s37 offen nt
    s_add_u32 s101, s101, 32768
    s_and_b32 s101, s101, 0x78000
    s_add_u32 s38, s38, 4096
    s_and_b32 s38, s38, 0x7000
    s_or_b32 s37, s101, s38
    s_add_u32 s37, s36, s37
    buffer_load_dwordx4 v[64:67], v1, s[8:11], s37 offen nt
    s_add_u32 s101, s101, 32768
    s_and_b32 s101, s101, 0x78000
    s_add_u32 s38, s38, 4096
    s_and_b32 s38, s38, 0x7000
    s_or_b32 s37, s101, s38
    s_add_u32 s37, s36, s37
    buffer_load_dwordx4 v[68:71], v1, s[8:11], s37 offen nt
    s_add_u32 s101, s101, 32768
    s_and_b32 s101, s101, 0x78000
    s_add_u32 s38, s38, 4096
    s_and_b32 s38, s38, 0x7000
    s_or_b32 s37, s101, s38
    s_add_u32 s37, s36, s37
    buffer_load_dwordx4 v[72:75], v1, s[8:11], s37 offen nt
    s_add_u32 s101, s101, 32768
    s_and_b32 s101, s101, 0x78000
    s_add_u32 s38, s38, 4096
    s_and_b32 s38, s38, 0x7000
    s_or_b32 s37, s101, s38
    s_add_u32 s37, s36, s37
    buffer_load_dwordx4 v[76:79], v1, s[8:11], s37 offen nt
    v_mov_b32 v201, s32
    v_mov_b32 v203, s32
    s_bitcmp1_b32 s3, 0
    s_cselect_b32 s92, 16, 1
    s_mov_b32 s93, 0
    s_barrier
    ds_read_b128 v[176:179], v8 offset:54272
    ds_read_b128 v[180:183], v8 offset:54288
    ds_read_b128 v[184:187], v8 offset:54528
    ds_read_b128 v[188:191], v8 offset:54544
    ds_read_b128 v[204:207], v2 offset:59392
    s_waitcnt lgkmcnt(0)
    v_min3_u32 v2, v204, v205, v206
    v_min_u32 v2, v2, v207
    s_nop 0
    v_readfirstlane_b32 s101, v2
    v_max3_f32 v8, v176, v177, v178
    v_max3_f32 v9, v179, v180, v181
    v_max3_f32 v8, v8, v182, v183
    v_max3_f32 v9, v9, v184, v185
    v_max3_f32 v8, v8, v186, v187
    v_max3_f32 v9, v9, v188, v189
    v_max3_f32 v8, v8, v190, v191
    v_max_f32 v8, v8, v9
    s_nop 1
    v_max_f32_dpp v8, v8, v8 quad_perm:[1,0,3,2] row_mask:0xf bank_mask:0xf
    v_mov_b32 v9, v8
    s_nop 1
    v_permlane16_swap_b32 v8, v9
    v_max_f32 v8, v8, v9
    v_mov_b32 v9, v8
    s_nop 1
    v_permlane32_swap_b32 v8, v9
    v_max_f32 v8, v8, v9
    v_mul_f32 v200, s100, v8
    v_fma_f32 v176, v176, s100, -v200
    v_fma_f32 v177, v177, s100, -v200
    v_fma_f32 v178, v178, s100, -v200
    v_fma_f32 v179, v179, s100, -v200
    v_fma_f32 v180, v180, s100, -v200
    v_fma_f32 v181, v181, s100, -v200
    v_fma_f32 v182, v182, s100, -v200
    v_fma_f32 v183, v183, s100, -v200
    v_fma_f32 v184, v184, s100, -v200
    v_fma_f32 v185, v185, s100, -v200
    v_fma_f32 v186, v186, s100, -v200
    v_fma_f32 v187, v187, s100, -v200
    v_fma_f32 v188, v188, s100, -v200
    v_fma_f32 v189, v189, s100, -v200
    v_fma_f32 v190, v190, s100, -v200
    v_fma_f32 v191, v191, s100, -v200
    v_exp_f32 v176, v176
    v_exp_f32 v177, v177
    v_exp_f32 v178, v178
    v_exp_f32 v179, v179
    v_exp_f32 v180, v180
    v_exp_f32 v181, v181
    v_exp_f32 v182, v182
    v_exp_f32 v183, v183
    v_exp_f32 v184, v184
    v_exp_f32 v185, v185
    v_exp_f32 v186, v186
    v_exp_f32 v187, v187
    v_exp_f32 v188, v188
    v_exp_f32 v189, v189
    v_exp_f32 v190, v190
    v_exp_f32 v191, v191
    v_cvt_pk_bf16_f32 v192, v176, v177
    v_cvt_pk_bf16_f32 v193, v178, v179
    v_cvt_pk_bf16_f32 v194, v180, v181
    v_cvt_pk_bf16_f32 v195, v182, v183
    v_cvt_pk_bf16_f32 v196, v184, v185
    v_cvt_pk_bf16_f32 v197, v186, v187
    v_cvt_pk_bf16_f32 v198, v188, v189
    v_cvt_pk_bf16_f32 v199, v190, v191
    v_add_f32 v176, v176, v184
    v_add_f32 v177, v177, v185
    v_add_f32 v178, v178, v186
    v_add_f32 v179, v179, v187
    v_add_f32 v180, v180, v188
    v_add_f32 v181, v181, v189
    v_add_f32 v182, v182, v190
    v_add_f32 v183, v183, v191
    v_add_f32 v176, v176, v180
    v_add_f32 v177, v177, v181
    v_add_f32 v178, v178, v182
    v_add_f32 v179, v179, v183
    v_add_f32 v176, v176, v178
    v_add_f32 v177, v177, v179
    v_add_f32 v202, v176, v177
    s_nop 1
    v_add_f32_dpp v202, v202, v202 quad_perm:[1,0,3,2] row_mask:0xf bank_mask:0xf
    v_mov_b32 v9, v202
    s_nop 1
    v_permlane16_swap_b32 v202, v9
    v_add_f32 v202, v202, v9
    v_mov_b32 v9, v202
    s_nop 1
    v_permlane32_swap_b32 v202, v9
    v_add_f32 v202, v202, v9
    s_waitcnt vmcnt(14)
    v_perm_b32 v80, v20, v16, s98
    v_perm_b32 v84, v20, v16, s99
    v_perm_b32 v88, v21, v17, s98
    v_perm_b32 v92, v21, v17, s99
    v_perm_b32 v96, v22, v18, s98
    v_perm_b32 v100, v22, v18, s99
    v_perm_b32 v104, v23, v19, s98
    v_perm_b32 v108, v23, v19, s99
    s_waitcnt vmcnt(12)
    v_perm_b32 v81, v28, v24, s98
    v_perm_b32 v85, v28, v24, s99
    v_perm_b32 v89, v29, v25, s98
    v_perm_b32 v93, v29, v25, s99
    v_perm_b32 v97, v30, v26, s98
    v_perm_b32 v101, v30, v26, s99
    v_perm_b32 v105, v31, v27, s98
    v_perm_b32 v109, v31, v27, s99
    s_waitcnt vmcnt(10)
    v_perm_b32 v82, v36, v32, s98
    v_perm_b32 v86, v36, v32, s99
    v_perm_b32 v90, v37, v33, s98
    v_perm_b32 v94, v37, v33, s99
    v_perm_b32 v98, v38, v34, s98
    v_perm_b32 v102, v38, v34, s99
    v_perm_b32 v106, v39, v35, s98
    v_perm_b32 v110, v39, v35, s99
    s_waitcnt vmcnt(8)
    v_perm_b32 v83, v44, v40, s98
    v_perm_b32 v87, v44, v40, s99
    v_perm_b32 v91, v45, v41, s98
    v_perm_b32 v95, v45, v41, s99
    v_perm_b32 v99, v46, v42, s98
    v_perm_b32 v103, v46, v42, s99
    v_perm_b32 v107, v47, v43, s98
    v_perm_b32 v111, v47, v43, s99
    v_mfma_f32_16x16x32_bf16 v[144:147], v[192:195], v[80:83], 0
    v_mfma_f32_16x16x32_bf16 v[148:151], v[192:195], v[84:87], 0
    v_mfma_f32_16x16x32_bf16 v[152:155], v[192:195], v[88:91], 0
    v_mfma_f32_16x16x32_bf16 v[156:159], v[192:195], v[92:95], 0
    v_mfma_f32_16x16x32_bf16 v[160:163], v[192:195], v[96:99], 0
    v_mfma_f32_16x16x32_bf16 v[164:167], v[192:195], v[100:103], 0
    v_mfma_f32_16x16x32_bf16 v[168:171], v[192:195], v[104:107], 0
    v_mfma_f32_16x16x32_bf16 v[172:175], v[192:195], v[108:111], 0
    s_waitcnt vmcnt(6)
    v_perm_b32 v112, v52, v48, s98
    v_perm_b32 v116, v52, v48, s99
    v_perm_b32 v120, v53, v49, s98
    v_perm_b32 v124, v53, v49, s99
    v_perm_b32 v128, v54, v50, s98
    v_perm_b32 v132, v54, v50, s99
    v_perm_b32 v136, v55, v51, s98
    v_perm_b32 v140, v55, v51, s99
    s_waitcnt vmcnt(4)
    v_perm_b32 v113, v60, v56, s98
    v_perm_b32 v117, v60, v56, s99
    v_perm_b32 v121, v61, v57, s98
    v_perm_b32 v125, v61, v57, s99
    v_perm_b32 v129, v62, v58, s98
    v_perm_b32 v133, v62, v58, s99
    v_perm_b32 v137, v63, v59, s98
    v_perm_b32 v141, v63, v59, s99
    s_waitcnt vmcnt(2)
    v_perm_b32 v114, v68, v64, s98
    v_perm_b32 v118, v68, v64, s99
    v_perm_b32 v122, v69, v65, s98
    v_perm_b32 v126, v69, v65, s99
    v_perm_b32 v130, v70, v66, s98
    v_perm_b32 v134, v70, v66, s99
    v_perm_b32 v138, v71, v67, s98
    v_perm_b32 v142, v71, v67, s99
    s_waitcnt vmcnt(0)
    v_perm_b32 v115, v76, v72, s98
    v_perm_b32 v119, v76, v72, s99
    v_perm_b32 v123, v77, v73, s98
    v_perm_b32 v127, v77, v73, s99
    v_perm_b32 v131, v78, v74, s98
    v_perm_b32 v135, v78, v74, s99
    v_perm_b32 v139, v79, v75, s98
    v_perm_b32 v143, v79, v75, s99
    v_mfma_f32_16x16x32_bf16 v[144:147], v[196:199], v[112:115], v[144:147]
    v_mfma_f32_16x16x32_bf16 v[148:151], v[196:199], v[116:119], v[148:151]
    v_mfma_f32_16x16x32_bf16 v[152:155], v[196:199], v[120:123], v[152:155]
    v_mfma_f32_16x16x32_bf16 v[156:159], v[196:199], v[124:127], v[156:159]
    v_mfma_f32_16x16x32_bf16 v[160:163], v[196:199], v[128:131], v[160:163]
    v_mfma_f32_16x16x32_bf16 v[164:167], v[196:199], v[132:135], v[164:167]
    v_mfma_f32_16x16x32_bf16 v[168:171], v[196:199], v[136:139], v[168:171]
    v_mfma_f32_16x16x32_bf16 v[172:175], v[196:199], v[140:143], v[172:175]
    s_cmp_eq_u32 s101, 2
    s_cbranch_scc0 V_REMOTE
    s_mov_b64 exec, s[92:93]
    buffer_store_dwordx4 v[200:203], v6, s[20:23], s95 offen
    s_mov_b64 exec, -1
    v_add_f32_dpp v176, v145, v144 row_ror:8 row_mask:0xf bank_mask:0xf
    v_add_f32_dpp v177, v149, v148 row_ror:8 row_mask:0xf bank_mask:0xf
    v_add_f32_dpp v178, v153, v152 row_ror:8 row_mask:0xf bank_mask:0xf
    v_add_f32_dpp v179, v157, v156 row_ror:8 row_mask:0xf bank_mask:0xf
    v_add_f32_dpp v180, v161, v160 row_ror:8 row_mask:0xf bank_mask:0xf
    v_add_f32_dpp v181, v165, v164 row_ror:8 row_mask:0xf bank_mask:0xf
    v_add_f32_dpp v182, v169, v168 row_ror:8 row_mask:0xf bank_mask:0xf
    v_add_f32_dpp v183, v173, v172 row_ror:8 row_mask:0xf bank_mask:0xf
    v_cvt_pk_bf16_f32 v208, v176, v177
    v_cvt_pk_bf16_f32 v209, v178, v179
    v_cvt_pk_bf16_f32 v210, v180, v181
    v_cvt_pk_bf16_f32 v211, v182, v183
    s_mov_b64 exec, 0x00ff00ff
    buffer_store_dwordx4 v[208:211], v7, s[20:23], s94 offen
V_PUB:
    s_mov_b64 exec, -1
    s_cmp_ge_u32 s29, 28
    s_cbranch_scc1 FINISH
    s_barrier
    s_barrier
    s_branch FINISH
K_MAIN:
    s_and_b32 s88, s29, 3
    s_lshr_b32 s89, s29, 2
    s_mov_b64 s[12:13], s[72:73]
    s_mov_b64 s[16:17], s[80:81]
    s_mov_b64 s[24:25], s[78:79]
    s_mov_b64 s[4:5], s[64:65]
    s_lshl_b32 s92, s3, 12
    s_lshl_b32 s90, s3, 2
    s_add_u32 s90, s90, s88
    s_mul_i32 s91, s28, 7
    s_add_u32 s91, s91, s90
    s_cmp_ge_u32 s29, 28
    s_cselect_b32 s90, 7, s90
    s_lshl_b32 s64, s28, 4
    s_lshl_b32 s97, s88, 2
    s_add_u32 s64, s64, s97
    s_add_u32 s64, s64, s3
    s_mul_i32 s64, s64, 28672
    s_lshl_b32 s97, s89, 7
    s_add_u32 s64, s64, s97
    s_mul_i32 s65, s91, 28672
    s_add_u32 s65, s65, s97
    s_lshl_b32 s94, s28, 16
    s_add_u32 s94, s94, s92
    s_lshl_b32 s95, s30, 9
    s_add_u32 s94, s94, s95
    s_lshr_b32 s94, s94, 1
    s_add_u32 s94, s94, 0x8000
    s_add_u32 s95, s94, 16384
    s_add_u32 s96, s94, 32768
    s_add_u32 s97, s94, 49152
    s_lshl_b32 s66, s28, 4
    s_add_u32 s66, s66, s90
    s_lshl_b32 s66, s66, 10
    s_add_u32 s66, s66, 0x88000
    s_lshl_b32 s67, s91, 6
    s_lshl_b32 s68, s28, 1
    s_lshr_b32 s99, s88, 1
    s_add_u32 s68, s68, s99
    s_lshl_b32 s68, s68, 9
    s_add_u32 s68, s68, 0x150000
    s_lshl_b32 s69, s28, 16
    s_lshl_b32 s99, s88, 14
    s_add_u32 s69, s69, s99
    s_add_u32 s69, s69, s92
    s_lshr_b32 s70, s69, 1
    s_add_u32 s70, s70, 0xd0000
    s_add_u32 s69, s69, 0x200000
    s_add_u32 s73, s66, 8192
    s_lshl_b32 s71, s89, 5
    s_lshl_b32 s99, s28, 2
    s_add_u32 s71, s71, s99
    s_add_u32 s71, s71, s88
    s_and_b32 s100, s3, 1
    s_lshl_b32 s71, s71, 1
    s_add_u32 s71, s71, s100
    s_lshl_b32 s71, s71, 10
    s_add_u32 s71, s71, 0x160000
    s_and_b32 s76, s28, 3
    s_mul_i32 s76, s76, 896
    s_lshl_b32 s99, s89, 7
    s_add_u32 s76, s76, s99
    s_lshr_b32 s99, s28, 2
    s_lshl_b32 s99, s99, 6
    s_add_u32 s76, s76, s99
    s_lshl_b32 s99, s88, 3
    s_add_u32 s76, s76, s99
    s_lshl_b32 s77, s28, 2
    s_add_u32 s77, s77, s88
    s_lshl_b32 s77, s77, 6
    s_lshl_b32 s99, s89, 16
    s_add_u32 s77, s77, s99
    s_add_u32 s77, s77, 0x160000
    v_lshlrev_b32 v204, 1, v5
    v_lshrrev_b32 v205, 2, v0
    v_lshlrev_b32 v205, 11, v205
    v_lshl_add_u32 v205, v5, 4, v205
    v_lshrrev_b32 v12, 2, v0
    v_lshlrev_b32 v12, 7, v12
    v_lshl_add_u32 v12, v5, 3, v12
    v_and_b32 v13, 3, v11
    v_lshl_add_u32 v12, v13, 5, v12
    v_xor_b32 v13, 32, v12
    v_xor_b32 v14, 64, v12
    v_xor_b32 v15, 96, v12
    v_add_u32 v12, s92, v12
    v_add_u32 v13, s92, v13
    v_add_u32 v14, s92, v14
    v_add_u32 v15, s92, v15
    v_mul_u32_u24 v212, 896, v11
    v_add_u32 v184, v212, v10
    v_and_b32 v6, 1, v4
    v_lshlrev_b32 v7, 1, v6
    v_xor_b32 v7, v7, v0
    v_and_b32 v7, 7, v7
    v_lshl_add_u32 v212, v7, 4, v212
    v_xor_b32 v213, 64, v212
    v_lshlrev_b32 v208, 10, v4
    v_lshl_add_u32 v208, v3, 7, v208
    v_lshl_add_u32 v208, v5, 3, v208
    v_lshl_add_u32 v208, v6, 6, v208
    v_bfe_u32 v6, v0, 3, 1
    v_lshl_add_u32 v208, v6, 5, v208
    v_add_u32 v208, s92, v208
    v_xor_b32 v209, 32, v208
    v_xor_b32 v210, 64, v208
    v_xor_b32 v211, 96, v208
    v_lshrrev_b32 v7, 5, v0
    v_bfe_u32 v9, v0, 4, 1
    v_lshlrev_b32 v6, 13, v7
    v_lshl_add_u32 v6, v9, 10, v6
    v_and_b32 v8, 15, v0
    v_lshl_add_u32 v185, v8, 4, v6
    v_lshlrev_b32 v6, 7, v9
    v_lshl_add_u32 v6, v5, 5, v6
    v_lshl_add_u32 v6, v3, 3, v6
    s_mov_b32 s86, 0x0c0c0400
    s_mov_b32 s87, 0x04000c0c
    s_lshl_b32 s98, s3, 8
    v_add_u32 v186, s98, v6
    v_bfe_u32 v6, v0, 2, 1
    v_lshlrev_b32 v6, 9, v6
    v_lshl_add_u32 v6, v4, 6, v6
    v_lshl_add_u32 v187, v5, 4, v6
    v_lshlrev_b32 v6, 9, v9
    v_lshl_add_u32 v6, v3, 5, v6
    s_lshl_b32 s98, s3, 7
    v_add_u32 v188, s98, v6
    v_and_b32 v6, 1, v0
    v_lshlrev_b32 v6, 5, v6
    v_lshl_add_u32 v189, v4, 3, v6
    v_lshlrev_b32 v6, 4, v5
    v_lshl_add_u32 v6, v3, 8, v6
    v_lshl_add_u32 v190, v4, 6, v6
    v_and_b32 v6, 7, v0
    v_lshl_add_u32 v6, v4, 3, v6
    v_lshlrev_b32 v191, 4, v6
    v_lshlrev_b32 v195, 4, v0
    s_lshl_b32 s98, s3, 10
    v_add_u32 v193, s98, v195
    s_lshl_b32 s98, s100, 3
    v_add_u32 v194, s98, v195
    s_lshl_b32 s98, s3, 2
    v_mov_b32 v196, s98
    v_mov_b32 v197, 0
    v_mov_b32 v156, 0
    v_mov_b32 v157, 0
    v_mov_b32 v158, 0
    v_mov_b32 v159, 0
    s_waitcnt lgkmcnt(0)
    s_mul_i32 s32, s32, 1664525
    s_add_u32 s32, s32, 1013904223
    v_mov_b32 v161, s32
    v_mov_b32 v163, s32
    s_mov_b64 exec, 1
    s_cmp_eq_u32 s3, 0
    s_cbranch_scc0 T1
    buffer_load_dword v214, v197, s[12:15], s64 offen
T1:
    s_cmp_eq_u32 s3, 1
    s_cbranch_scc0 T2
    buffer_load_dword v214, v197, s[16:19], s65 offen
T2:
    s_cmp_eq_u32 s3, 2
    s_cbranch_scc0 T3
    global_load_dword v214, v197, s[82:83]
T3:
    s_cmp_eq_u32 s3, 3
    s_cbranch_scc0 T4
    buffer_load_dword v214, v197, s[24:27], 0 offen
T4:
    s_mov_b64 exec, -1
    s_barrier
    s_or_b32 s37, s93, s38
    s_add_u32 s37, s36, s37
    buffer_load_dwordx4 v[40:43], v1, s[8:11], s37 offen offset:0 nt
    buffer_load_dwordx4 v[44:47], v1, s[8:11], s37 offen offset:256 nt
    s_add_u32 s93, s93, 32768
    s_and_b32 s93, s93, 0x78000
    s_add_u32 s38, s38, 4096
    s_and_b32 s38, s38, 0x7000
    s_or_b32 s37, s93, s38
    s_add_u32 s37, s36, s37
    buffer_load_dwordx4 v[48:51], v1, s[8:11], s37 offen offset:0 nt
    buffer_load_dwordx4 v[52:55], v1, s[8:11], s37 offen offset:256 nt
    s_add_u32 s93, s93, 32768
    s_and_b32 s93, s93, 0x78000
    s_add_u32 s38, s38, 4096
    s_and_b32 s38, s38, 0x7000
    s_or_b32 s37, s93, s38
    s_add_u32 s37, s36, s37
    buffer_load_dwordx4 v[56:59], v1, s[8:11], s37 offen offset:0 nt
    buffer_load_dwordx4 v[60:63], v1, s[8:11], s37 offen offset:256 nt
    s_add_u32 s93, s93, 32768
    s_and_b32 s93, s93, 0x78000
    s_add_u32 s38, s38, 4096
    s_and_b32 s38, s38, 0x7000
    s_or_b32 s37, s93, s38
    s_add_u32 s37, s36, s37
    buffer_load_dwordx4 v[64:67], v1, s[8:11], s37 offen offset:0 nt
    buffer_load_dwordx4 v[68:71], v1, s[8:11], s37 offen offset:256 nt
    s_add_u32 s93, s93, 32768
    s_and_b32 s93, s93, 0x78000
    s_add_u32 s38, s38, 4096
    s_and_b32 s38, s38, 0x7000
    s_or_b32 s37, s93, s38
    s_add_u32 s37, s36, s37
    buffer_load_dwordx4 v[72:75], v1, s[8:11], s37 offen offset:0 nt
    buffer_load_dwordx4 v[76:79], v1, s[8:11], s37 offen offset:256 nt
    s_barrier
    buffer_load_dwordx4 v[84:87], v185, s[20:23], s94 offen sc1
    buffer_load_dwordx4 v[88:91], v185, s[20:23], s95 offen sc1
    s_waitcnt vmcnt(0)
PQ_chk:
    v_perm_b32 v92, v85, v84, s86
    v_perm_b32 v93, v87, v86, s87
    v_or_b32 v92, v92, v93
    v_perm_b32 v94, v89, v88, s86
    v_perm_b32 v95, v91, v90, s87
    v_or_b32 v94, v94, v95
    v_xor_b32 v92, s32, v92
    v_cmpx_gt_u32 vcc, 16, v92
    v_xor_b32 v94, s32, v94
    v_cmpx_gt_u32 vcc, 16, v94
    s_cmp_eq_u64 exec, -1
    s_mov_b64 exec, -1
    s_cbranch_scc0 PQ_retry
PQ_ok:
    s_nop 2
    v_and_b32 v84, 0xffffff00, v84
    v_and_b32 v85, 0xffffff00, v85
    v_and_b32 v86, 0xffffff00, v86
    v_and_b32 v87, 0xffffff00, v87
    v_and_b32 v88, 0xffffff00, v88
    v_and_b32 v89, 0xffffff00, v89
    v_and_b32 v90, 0xffffff00, v90
    v_and_b32 v91, 0xffffff00, v91
    v_add_f32 v84, v84, v88
    v_add_f32 v85, v85, v89
    v_add_f32 v86, v86, v90
    v_add_f32 v87, v87, v91
    v_mov_b32 v88, v84
    v_mov_b32 v89, v85
    v_mov_b32 v90, v86
    v_mov_b32 v91, v87
    v_permlane32_swap_b32 v84, v88
    v_permlane32_swap_b32 v85, v89
    v_permlane32_swap_b32 v86, v90
    v_permlane32_swap_b32 v87, v91
    v_add_f32 v84, v84, v88
    v_add_f32 v85, v85, v89
    v_add_f32 v86, v86, v90
    v_add_f32 v87, v87, v91
    v_cvt_pk_bf16_f32 v84, v84, v85
    v_cvt_pk_bf16_f32 v85, v86, v87
    ds_write_b64 v186, v[84:85] offset:53248
    v_cmpx_eq_u32 vcc, s34, v92
    v_cmpx_eq_u32 vcc, s34, v94
    s_cmp_eq_u64 exec, -1
    s_mov_b64 exec, -1
    s_cbranch_scc0 K_COPYB
K_COPYB_ret:
    s_cselect_b32 s98, 2, 1
    v_mov_b32 v82, s98
    s_waitcnt lgkmcnt(0)
    ds_write_b32 v196, v82 offset:59392
    s_mov_b32 s99, 16000000
PF:
    ds_read_b128 v[88:91], v197 offset:59392
    s_waitcnt lgkmcnt(0)
    v_min3_u32 v82, v88, v89, v90
    v_min_u32 v82, v82, v91
    s_nop 0
    v_readfirstlane_b32 s101, v82
    s_cmp_lg_u32 s101, 0
    s_cbranch_scc1 PF_ok
    s_sub_u32 s99, s99, 1
    s_cbranch_scc0 PF
PF_ok:
    ds_read_b128 v[92:95], v187 offset:53248
    ds_read_b128 v[96:99], v187 offset:53504
    s_waitcnt lgkmcnt(0)
    v_mfma_f32_16x16x32_bf16 v[116:119], v[92:95], v[16:19], 0
    v_mfma_f32_16x16x32_bf16 v[120:123], v[92:95], v[24:27], 0
    v_mfma_f32_16x16x32_bf16 v[124:127], v[92:95], v[32:35], 0
    v_mfma_f32_16x16x32_bf16 v[128:131], v[92:95], v[40:43], 0
    v_mfma_f32_16x16x32_bf16 v[132:135], v[92:95], v[48:51], 0
    v_mfma_f32_16x16x32_bf16 v[136:139], v[92:95], v[56:59], 0
    v_mfma_f32_16x16x32_bf16 v[140:143], v[92:95], v[64:67], 0
    v_mfma_f32_16x16x32_bf16 v[144:147], v[92:95], v[72:75], 0
    v_mfma_f32_16x16x32_bf16 v[116:119], v[96:99], v[20:23], v[116:119]
    v_mfma_f32_16x16x32_bf16 v[120:123], v[96:99], v[28:31], v[120:123]
    v_mfma_f32_16x16x32_bf16 v[124:127], v[96:99], v[36:39], v[124:127]
    v_mfma_f32_16x16x32_bf16 v[128:131], v[96:99], v[44:47], v[128:131]
    v_mfma_f32_16x16x32_bf16 v[132:135], v[96:99], v[52:55], v[132:135]
    v_mfma_f32_16x16x32_bf16 v[136:139], v[96:99], v[60:63], v[136:139]
    v_mfma_f32_16x16x32_bf16 v[140:143], v[96:99], v[68:71], v[140:143]
    v_mfma_f32_16x16x32_bf16 v[144:147], v[96:99], v[76:79], v[144:147]
    s_nop 0
    v_mov_b32_dpp v148, v116 quad_perm:[0,0,0,0] row_mask:0xf bank_mask:0xf
    v_mov_b32_dpp v149, v120 quad_perm:[0,0,0,0] row_mask:0xf bank_mask:0xf
    v_mov_b32_dpp v150, v124 quad_perm:[0,0,0,0] row_mask:0xf bank_mask:0xf
    v_mov_b32_dpp v151, v128 quad_perm:[0,0,0,0] row_mask:0xf bank_mask:0xf
    v_mov_b32_dpp v152, v132 quad_perm:[0,0,0,0] row_mask:0xf bank_mask:0xf
    v_mov_b32_dpp v153, v136 quad_perm:[0,0,0,0] row_mask:0xf bank_mask:0xf
    v_mov_b32_dpp v154, v140 quad_perm:[0,0,0,0] row_mask:0xf bank_mask:0xf
    v_mov_b32_dpp v155, v144 quad_perm:[0,0,0,0] row_mask:0xf bank_mask:0xf
    v_add_f32_dpp v148, v117, v148 quad_perm:[1,1,1,1] row_mask:0xf bank_mask:0xf
    v_add_f32_dpp v149, v121, v149 quad_perm:[1,1,1,1] row_mask:0xf bank_mask:0xf
    v_add_f32_dpp v150, v125, v150 quad_perm:[1,1,1,1] row_mask:0xf bank_mask:0xf
    v_add_f32_dpp v151, v129, v151 quad_perm:[1,1,1,1] row_mask:0xf bank_mask:0xf
    v_add_f32_dpp v152, v133, v152 quad_perm:[1,1,1,1] row_mask:0xf bank_mask:0xf
    v_add_f32_dpp v153, v137, v153 quad_perm:[1,1,1,1] row_mask:0xf bank_mask:0xf
    v_add_f32_dpp v154, v141, v154 quad_perm:[1,1,1,1] row_mask:0xf bank_mask:0xf
    v_add_f32_dpp v155, v145, v155 quad_perm:[1,1,1,1] row_mask:0xf bank_mask:0xf
    v_add_f32_dpp v148, v118, v148 quad_perm:[2,2,2,2] row_mask:0xf bank_mask:0xf
    v_add_f32_dpp v149, v122, v149 quad_perm:[2,2,2,2] row_mask:0xf bank_mask:0xf
    v_add_f32_dpp v150, v126, v150 quad_perm:[2,2,2,2] row_mask:0xf bank_mask:0xf
    v_add_f32_dpp v151, v130, v151 quad_perm:[2,2,2,2] row_mask:0xf bank_mask:0xf
    v_add_f32_dpp v152, v134, v152 quad_perm:[2,2,2,2] row_mask:0xf bank_mask:0xf
    v_add_f32_dpp v153, v138, v153 quad_perm:[2,2,2,2] row_mask:0xf bank_mask:0xf
    v_add_f32_dpp v154, v142, v154 quad_perm:[2,2,2,2] row_mask:0xf bank_mask:0xf
    v_add_f32_dpp v155, v146, v155 quad_perm:[2,2,2,2] row_mask:0xf bank_mask:0xf
    v_add_f32_dpp v148, v119, v148 quad_perm:[3,3,3,3] row_mask:0xf bank_mask:0xf
    v_add_f32_dpp v149, v123, v149 quad_perm:[3,3,3,3] row_mask:0xf bank_mask:0xf
    v_add_f32_dpp v150, v127, v150 quad_perm:[3,3,3,3] row_mask:0xf bank_mask:0xf
    v_add_f32_dpp v151, v131, v151 quad_perm:[3,3,3,3] row_mask:0xf bank_mask:0xf
    v_add_f32_dpp v152, v135, v152 quad_perm:[3,3,3,3] row_mask:0xf bank_mask:0xf
    v_add_f32_dpp v153, v139, v153 quad_perm:[3,3,3,3] row_mask:0xf bank_mask:0xf
    v_add_f32_dpp v154, v143, v154 quad_perm:[3,3,3,3] row_mask:0xf bank_mask:0xf
    v_add_f32_dpp v155, v147, v155 quad_perm:[3,3,3,3] row_mask:0xf bank_mask:0xf
    ds_write_b128 v188, v[148:151] offset:54272
    ds_write_b128 v188, v[152:155] offset:54288
    s_cmp_eq_u32 s101, 2
    s_cselect_b32 s98, 0, 0x130000
    s_add_u32 s68, s68, s98
    s_waitcnt lgkmcnt(0)
    s_barrier
    s_cmp_eq_u32 s101, 2
    s_cbranch_scc0 K_COPYB2
K_COPYB2_ret:
    s_cmp_ge_u32 s29, 28
    s_cbranch_scc1 KFINISH
    s_cmp_lg_u32 s3, 2
    s_cbranch_scc1 K_NOX
    buffer_load_ushort v206, v204, s[4:7], s76 offen
    buffer_load_ushort v207, v204, s[4:7], s76 offen offset:32
K_NOX:
    s_cmp_ge_u32 s90, 7
    s_cbranch_scc1 K_NOH
    buffer_load_dwordx2 v[164:165], v189, s[24:27], s67 offen
    buffer_load_dwordx4 v[168:171], v190, s[20:23], s66 offen sc1
    buffer_load_dwordx4 v[172:175], v190, s[20:23], s73 offen sc1
K_NOH:
    s_add_u32 m0, s92, 28672
    s_nop 0
    buffer_load_dwordx4 v212, s[12:15], s64 offen nt lds
    s_add_u32 m0, m0, 1024
    s_add_u32 s64, s64, 7168
    buffer_load_dwordx4 v213, s[12:15], s64 offen nt lds
    s_add_u32 m0, m0, 1024
    s_add_u32 s64, s64, 7168
    buffer_load_dwordx4 v212, s[12:15], s64 offen nt lds
    s_add_u32 m0, m0, 1024
    s_add_u32 s64, s64, 7168
    buffer_load_dwordx4 v213, s[12:15], s64 offen nt lds
    s_cmp_ge_u32 s90, 7
    s_cbranch_scc1 K_W2
    s_add_u32 m0, s92, 45056
    s_nop 0
    buffer_load_dwordx4 v184, s[16:19], s65 offen nt lds
    s_add_u32 m0, m0, 1024
    s_add_u32 s65, s65, 7168
    buffer_load_dwordx4 v184, s[16:19], s65 offen nt lds
    s_add_u32 m0, m0, 1024
    s_add_u32 s65, s65, 7168
    buffer_load_dwordx4 v184, s[16:19], s65 offen nt lds
    s_add_u32 m0, m0, 1024
    s_add_u32 s65, s65, 7168
    buffer_load_dwordx4 v184, s[16:19], s65 offen nt lds
K_W2:
    s_barrier
    s_cmp_eq_u32 s101, 2
    s_cbranch_scc0 K_REMOTE
    buffer_load_dwordx4 v[100:103], v195, s[20:23], s70 offen offset:0 sc1
    buffer_load_dwordx4 v[108:111], v195, s[20:23], s70 offen offset:1024 sc1
    buffer_load_dwordx4 v[200:203], v191, s[20:23], s68 offen offset:0 sc1
K_WF:
    s_cmp_ge_u32 s90, 7
    s_cbranch_scc1 NOMLP1
    s_waitcnt vmcnt(11)
PH_chk:
    v_perm_b32 v176, v169, v168, s86
    v_perm_b32 v177, v171, v170, s87
    v_or_b32 v176, v176, v177
    v_perm_b32 v178, v173, v172, s86
    v_perm_b32 v179, v175, v174, s87
    v_or_b32 v178, v178, v179
    v_xor_b32 v176, s32, v176
    v_cmpx_gt_u32 vcc, 16, v176
    v_xor_b32 v178, s32, v178
    v_cmpx_gt_u32 vcc, 16, v178
    s_cmp_eq_u64 exec, -1
    s_mov_b64 exec, -1
    s_cbranch_scc0 PH_retry
PH_ok:
    v_and_b32 v168, 0xffffff00, v168
    v_and_b32 v169, 0xffffff00, v169
    v_and_b32 v170, 0xffffff00, v170
    v_and_b32 v171, 0xffffff00, v171
    v_and_b32 v172, 0xffffff00, v172
    v_and_b32 v173, 0xffffff00, v173
    v_and_b32 v174, 0xffffff00, v174
    v_and_b32 v175, 0xffffff00, v175
    v_add_f32 v168, v168, v172
    v_add_f32 v169, v169, v173
    v_add_f32 v170, v170, v174
    v_add_f32 v171, v171, v175
    v_lshlrev_b32 v172, 16, v164
    v_and_b32 v173, 0xffff0000, v164
    v_lshlrev_b32 v174, 16, v165
    v_and_b32 v175, 0xffff0000, v165
    v_add_f32_dpp v168, v168, v168 quad_perm:[2,3,0,1] row_mask:0xf bank_mask:0xf
    v_add_f32_dpp v169, v169, v169 quad_perm:[2,3,0,1] row_mask:0xf bank_mask:0xf
    v_add_f32_dpp v170, v170, v170 quad_perm:[2,3,0,1] row_mask:0xf bank_mask:0xf
    v_add_f32_dpp v171, v171, v171 quad_perm:[2,3,0,1] row_mask:0xf bank_mask:0xf
    v_add_f32 v168, v168, v172
    v_add_f32 v169, v169, v173
    v_add_f32 v170, v170, v174
    v_add_f32 v171, v171, v175
    s_mov_b32 s96, 0xbfb8aa3b
    v_mul_f32 v172, s96, |v168|
    v_mul_f32 v173, s96, |v169|
    v_mul_f32 v174, s96, |v170|
    v_mul_f32 v175, s96, |v171|
    v_exp_f32 v172, v172
    v_exp_f32 v173, v173
    v_exp_f32 v174, v174
    v_exp_f32 v175, v175
    v_cmp_lt_f32 vcc, 0, v168
    v_mul_f32 v16, v172, v172
    s_nop 0
    v_cndmask_b32 v24, 1.0, v16, vcc
    v_cndmask_b32_e64 v16, v16, 1.0, vcc
    v_fma_f32 v16, v172, 2.0, v16
    v_fma_f32 v24, v24, 2.0, v16
    v_cmp_lt_f32 vcc, 0, v169
    v_mul_f32 v17, v173, v173
    s_nop 0
    v_cndmask_b32 v25, 1.0, v17, vcc
    v_cndmask_b32_e64 v17, v17, 1.0, vcc
    v_fma_f32 v17, v173, 2.0, v17
    v_fma_f32 v25, v25, 2.0, v17
    v_cmp_lt_f32 vcc, 0, v170
    v_mul_f32 v18, v174, v174
    s_nop 0
    v_cndmask_b32 v26, 1.0, v18, vcc
    v_cndmask_b32_e64 v18, v18, 1.0, vcc
    v_fma_f32 v18, v174, 2.0, v18
    v_fma_f32 v26, v26, 2.0, v18
    v_cmp_lt_f32 vcc, 0, v171
    v_mul_f32 v19, v175, v175
    s_nop 0
    v_cndmask_b32 v27, 1.0, v19, vcc
    v_cndmask_b32_e64 v19, v19, 1.0, vcc
    v_fma_f32 v19, v175, 2.0, v19
    v_fma_f32 v27, v27, 2.0, v19
    v_rcp_f32 v24, v24
    v_rcp_f32 v25, v25
    v_rcp_f32 v26, v26
    v_rcp_f32 v27, v27
    v_mul_f32 v168, v168, v16
    v_mul_f32 v169, v169, v17
    v_mul_f32 v170, v170, v18
    v_mul_f32 v171, v171, v19
    v_mul_f32 v168, v168, v24
    v_mul_f32 v169, v169, v25
    v_mul_f32 v170, v170, v26
    v_mul_f32 v171, v171, v27
    v_cvt_pk_bf16_f32 v168, v168, v169
    v_cvt_pk_bf16_f32 v169, v170, v171
    s_nop 0
    v_mov_b32_dpp v80, v168 quad_perm:[0,0,0,0] row_mask:0xf bank_mask:0xf
    v_mov_b32_dpp v81, v169 quad_perm:[0,0,0,0] row_mask:0xf bank_mask:0xf
    v_mov_b32_dpp v82, v168 quad_perm:[1,1,1,1] row_mask:0xf bank_mask:0xf
    v_mov_b32_dpp v83, v169 quad_perm:[1,1,1,1] row_mask:0xf bank_mask:0xf
NOMLP1:
    s_waitcnt vmcnt(3)
    ds_read_b64_tr_b16 v[116:117], v208 offset:28672
    ds_read_b64_tr_b16 v[118:119], v208 offset:29184
    ds_read_b64_tr_b16 v[120:121], v209 offset:28672
    ds_read_b64_tr_b16 v[122:123], v209 offset:29184
    ds_read_b64_tr_b16 v[124:125], v210 offset:28672
    ds_read_b64_tr_b16 v[126:127], v210 offset:29184
    ds_read_b64_tr_b16 v[128:129], v211 offset:28672
    ds_read_b64_tr_b16 v[130:131], v211 offset:29184
    s_cmp_ge_u32 s90, 7
    s_cbranch_scc1 NOMLP2
    ds_read_b64_tr_b16 v[132:133], v12 offset:45056
    ds_read_b64_tr_b16 v[134:135], v12 offset:47104
    ds_read_b64_tr_b16 v[136:137], v13 offset:45056
    ds_read_b64_tr_b16 v[138:139], v13 offset:47104
    ds_read_b64_tr_b16 v[140:141], v14 offset:45056
    ds_read_b64_tr_b16 v[142:143], v14 offset:47104
    ds_read_b64_tr_b16 v[144:145], v15 offset:45056
    ds_read_b64_tr_b16 v[146:147], v15 offset:47104
    s_waitcnt lgkmcnt(0)
    v_mfma_f32_16x16x32_bf16 v[48:51], v[80:83], v[132:135], 0
    v_mfma_f32_16x16x32_bf16 v[52:55], v[80:83], v[136:139], 0
    v_mfma_f32_16x16x32_bf16 v[56:59], v[80:83], v[140:143], 0
    v_mfma_f32_16x16x32_bf16 v[60:63], v[80:83], v[144:147], 0
    s_nop 4
    v_mov_b32 v156, v48
    v_mov_b32 v157, v52
    v_mov_b32 v158, v56
    v_mov_b32 v159, v60
NOMLP2:
    s_waitcnt vmcnt(0)
PO_chk:
    v_max3_u32 v104, v100, v101, v102
    v_max_u32 v104, v104, v103
    v_cmp_eq_u32 s[94:95], -1, v104
    v_max3_u32 v112, v108, v109, v110
    v_max_u32 v112, v112, v111
    v_cmp_eq_u32 s[96:97], -1, v112
    v_cmp_ne_u32 vcc, s32, v201
    v_cmp_ne_u32 s[98:99], s32, v203
    s_or_b64 s[98:99], s[98:99], vcc
    s_or_b64 vcc, s[94:95], s[96:97]
    s_or_b64 vcc, vcc, s[98:99]
    s_cbranch_scc1 PO_retry
PO_ok:
    v_mov_b32 v201, v200
    s_waitcnt lgkmcnt(0)
    v_mfma_f32_16x16x32_bf16 v[16:19], v[100:103], v[116:119], 0
    v_max_f32_dpp v201, v201, v201 quad_perm:[1,0,3,2] row_mask:0xf bank_mask:0xf
    v_mfma_f32_16x16x32_bf16 v[20:23], v[100:103], v[120:123], 0
    s_nop 0
    v_max_f32_dpp v201, v201, v201 quad_perm:[2,3,0,1] row_mask:0xf bank_mask:0xf
    v_mfma_f32_16x16x32_bf16 v[24:27], v[100:103], v[124:127], 0
    s_nop 0
    v_max_f32_dpp v201, v201, v201 row_half_mirror row_mask:0xf bank_mask:0xf
    v_mfma_f32_16x16x32_bf16 v[28:31], v[100:103], v[128:131], 0
    v_sub_f32 v200, v200, v201
    v_exp_f32 v200, v200
    v_mfma_f32_16x16x32_bf16 v[32:35], v[108:111], v[116:119], 0
    v_mul_f32 v202, v202, v200
    v_mfma_f32_16x16x32_bf16 v[36:39], v[108:111], v[120:123], 0
    s_nop 0
    v_add_f32_dpp v202, v202, v202 quad_perm:[1,0,3,2] row_mask:0xf bank_mask:0xf
    v_mfma_f32_16x16x32_bf16 v[40:43], v[108:111], v[124:127], 0
    s_nop 0
    v_add_f32_dpp v202, v202, v202 quad_perm:[2,3,0,1] row_mask:0xf bank_mask:0xf
    v_mfma_f32_16x16x32_bf16 v[44:47], v[108:111], v[128:131], 0
    s_nop 0
    v_add_f32_dpp v202, v202, v202 row_half_mirror row_mask:0xf bank_mask:0xf
    v_rcp_f32 v202, v202
    s_nop 0
    v_mul_f32 v200, v200, v202
    s_nop 1
    v_fmac_f32_dpp v156, v200, v16 row_newbcast:0 row_mask:0xf bank_mask:0xf
    v_fmac_f32_dpp v157, v200, v20 row_newbcast:0 row_mask:0xf bank_mask:0xf
    v_fmac_f32_dpp v158, v200, v24 row_newbcast:0 row_mask:0xf bank_mask:0xf
    v_fmac_f32_dpp v159, v200, v28 row_newbcast:0 row_mask:0xf bank_mask:0xf
    v_fmac_f32_dpp v156, v200, v17 row_newbcast:1 row_mask:0xf bank_mask:0xf
    v_fmac_f32_dpp v157, v200, v21 row_newbcast:1 row_mask:0xf bank_mask:0xf
    v_fmac_f32_dpp v158, v200, v25 row_newbcast:1 row_mask:0xf bank_mask:0xf
    v_fmac_f32_dpp v159, v200, v29 row_newbcast:1 row_mask:0xf bank_mask:0xf
    v_fmac_f32_dpp v156, v200, v18 row_newbcast:2 row_mask:0xf bank_mask:0xf
    v_fmac_f32_dpp v157, v200, v22 row_newbcast:2 row_mask:0xf bank_mask:0xf
    v_fmac_f32_dpp v158, v200, v26 row_newbcast:2 row_mask:0xf bank_mask:0xf
    v_fmac_f32_dpp v159, v200, v30 row_newbcast:2 row_mask:0xf bank_mask:0xf
    v_fmac_f32_dpp v156, v200, v19 row_newbcast:3 row_mask:0xf bank_mask:0xf
    v_fmac_f32_dpp v157, v200, v23 row_newbcast:3 row_mask:0xf bank_mask:0xf
    v_fmac_f32_dpp v158, v200, v27 row_newbcast:3 row_mask:0xf bank_mask:0xf
    v_fmac_f32_dpp v159, v200, v31 row_newbcast:3 row_mask:0xf bank_mask:0xf
    v_fmac_f32_dpp v156, v200, v32 row_newbcast:4 row_mask:0xf bank_mask:0xf
    v_fmac_f32_dpp v157, v200, v36 row_newbcast:4 row_mask:0xf bank_mask:0xf
    v_fmac_f32_dpp v158, v200, v40 row_newbcast:4 row_mask:0xf bank_mask:0xf
    v_fmac_f32_dpp v159, v200, v44 row_newbcast:4 row_mask:0xf bank_mask:0xf
    v_fmac_f32_dpp v156, v200, v33 row_newbcast:5 row_mask:0xf bank_mask:0xf
    v_fmac_f32_dpp v157, v200, v37 row_newbcast:5 row_mask:0xf bank_mask:0xf
    v_fmac_f32_dpp v158, v200, v41 row_newbcast:5 row_mask:0xf bank_mask:0xf
    v_fmac_f32_dpp v159, v200, v45 row_newbcast:5 row_mask:0xf bank_mask:0xf
    v_fmac_f32_dpp v156, v200, v34 row_newbcast:6 row_mask:0xf bank_mask:0xf
    v_fmac_f32_dpp v157, v200, v38 row_newbcast:6 row_mask:0xf bank_mask:0xf
    v_fmac_f32_dpp v158, v200, v42 row_newbcast:6 row_mask:0xf bank_mask:0xf
    v_fmac_f32_dpp v159, v200, v46 row_newbcast:6 row_mask:0xf bank_mask:0xf
    v_fmac_f32_dpp v156, v200, v35 row_newbcast:7 row_mask:0xf bank_mask:0xf
    v_fmac_f32_dpp v157, v200, v39 row_newbcast:7 row_mask:0xf bank_mask:0xf
    v_fmac_f32_dpp v158, v200, v43 row_newbcast:7 row_mask:0xf bank_mask:0xf
    v_fmac_f32_dpp v159, v200, v47 row_newbcast:7 row_mask:0xf bank_mask:0xf
    ds_write_b128 v193, v[156:159] offset:55296
    s_waitcnt lgkmcnt(0)
    s_barrier
    ds_read_b64 v[16:17], v194 offset:55296
    ds_read_b64 v[18:19], v194 offset:56320
    ds_read_b64 v[20:21], v194 offset:57344
    ds_read_b64 v[22:23], v194 offset:58368
    s_waitcnt lgkmcnt(0)
    v_add_f32 v16, v16, v18
    v_add_f32 v17, v17, v19
    v_add_f32 v20, v20, v22
    v_add_f32 v21, v21, v23
    v_add_f32 v160, v16, v20
    v_add_f32 v162, v17, v21
    s_cmp_lt_u32 s3, 2
    s_cbranch_scc1 KFINISH
    buffer_store_dwordx4 v[160:163], v195, s[20:23], s71 offen sc1
    s_cmp_lg_u32 s3, 2
    s_cbranch_scc1 KFINISH
    s_mov_b64 s[24:25], s[82:83]
    v_lshlrev_b32 v206, 16, v206
    v_lshlrev_b32 v207, 16, v207
    s_mov_b64 s[94:95], -1
    s_mov_b64 s[96:97], -1
    s_add_u32 s78, s77, 32768
    s_waitcnt vmcnt(0)
PR:
    s_mov_b64 exec, s[94:95]
    s_cbranch_execz PR_s0
    buffer_load_dwordx4 v[20:23], v205, s[20:23], s77 offen sc1
PR_s0:
    s_mov_b64 exec, s[96:97]
    s_cbranch_execz PR_s1
    buffer_load_dwordx4 v[24:27], v205, s[20:23], s78 offen sc1
PR_s1:
    s_mov_b64 exec, -1
    s_waitcnt vmcnt(0)
PR_chk:
    v_cmp_ne_u32 vcc, s32, v21
    v_cmp_ne_u32 s[94:95], s32, v23
    s_or_b64 s[94:95], s[94:95], vcc
    v_cmp_ne_u32 vcc, s32, v25
    v_cmp_ne_u32 s[96:97], s32, v27
    s_or_b64 s[96:97], s[96:97], vcc
    v_add_f32 v18, v20, v24
    v_add_f32 v19, v22, v26
    s_or_b64 vcc, s[94:95], s[96:97]
    s_cbranch_scc0 PR_ok
    s_cmp_eq_u32 s33, 0
    s_cbranch_scc1 PR_ok
    s_sub_u32 s33, s33, 1
    s_branch PR
PR_ok:
    v_add_f32_dpp v18, v18, v18 row_ror:4 row_mask:0xf bank_mask:0xf
    v_add_f32_dpp v19, v19, v19 row_ror:4 row_mask:0xf bank_mask:0xf
    s_nop 0
    v_add_f32_dpp v18, v18, v18 row_ror:8 row_mask:0xf bank_mask:0xf
    v_add_f32_dpp v19, v19, v19 row_ror:8 row_mask:0xf bank_mask:0xf
    v_mov_b32 v8, v18
    v_mov_b32 v9, v19
    s_nop 0
    v_permlane16_swap_b32 v18, v8
    v_permlane16_swap_b32 v19, v9
    v_add_f32 v18, v18, v8
    v_add_f32 v19, v19, v9
    v_mov_b32 v8, v18
    v_mov_b32 v9, v19
    s_nop 0
    v_permlane32_swap_b32 v18, v8
    v_permlane32_swap_b32 v19, v9
    v_add_f32 v18, v18, v8
    v_add_f32 v19, v19, v9
    v_add_f32 v18, v18, v206
    v_add_f32 v19, v19, v207
    v_cvt_pk_bf16_f32 v18, v18, v19
    s_mov_b64 exec, 0xf
    buffer_store_short v18, v204, s[24:27], s76 offen
    buffer_store_short_d16_hi v18, v204, s[24:27], s76 offen offset:32
    s_mov_b64 exec, -1
    s_cmp_lg_u32 s2, 0
    s_cbranch_scc1 KFINISH
    v_mov_b32 v8, s32
    s_mov_b64 exec, 1
    buffer_store_dword v8, v197, s[20:23], 0 offen
    s_mov_b64 exec, -1
KFINISH:
FINISH:
EXIT:
    s_endpgm
PQ_retry:
    s_cmp_eq_u32 s33, 0
    s_cbranch_scc1 PQ_ok
    s_sub_u32 s33, s33, 1
    s_sleep 1
    buffer_load_dwordx4 v[84:87], v185, s[20:23], s94 offen sc1
    buffer_load_dwordx4 v[88:91], v185, s[20:23], s95 offen sc1
    s_xor_b32 s94, s94, 0x400000
    s_xor_b32 s95, s95, 0x400000
    s_bitcmp1_b32 s94, 22
    s_cbranch_scc1 PQ_nocopy
    s_lshl_b32 s98, s39, 10
    s_add_u32 s98, s98, 0x8000
    s_lshl_b32 s99, s28, 1
    s_lshr_b32 s100, s30, 1
    s_add_u32 s99, s99, s100
    s_lshl_b32 s99, s99, 3
    s_add_u32 s99, s99, s31
    s_lshl_b32 s99, s99, 10
    s_add_u32 s99, s99, 0x88000
    buffer_load_dwordx4 v[116:119], v195, s[20:23], s98 offen sc1
    buffer_load_dwordx4 v[124:127], v195, s[20:23], s99 offen sc1
    s_add_u32 s98, s98, 0x400000
    s_add_u32 s99, s99, 0x400000
    s_waitcnt vmcnt(0)
    buffer_store_dwordx4 v[116:119], v195, s[20:23], s98 offen sc1
    s_and_b32 s100, s30, 1
    s_lshl_b32 s100, s100, 1
    s_lshl_b32 exec_lo, 0x33333333, s100
    s_mov_b32 exec_hi, exec_lo
    buffer_store_dwordx4 v[124:127], v195, s[20:23], s99 offen sc1
    s_mov_b64 exec, -1
PQ_nocopy:
    s_waitcnt vmcnt(0)
    s_branch PQ_chk
PH_retry:
    s_cmp_eq_u32 s33, 0
    s_cbranch_scc1 PH_ok
    s_sub_u32 s33, s33, 1
    s_sleep 1
    buffer_load_dwordx4 v[168:171], v190, s[20:23], s66 offen sc1
    buffer_load_dwordx4 v[172:175], v190, s[20:23], s73 offen sc1
    s_xor_b32 s66, s66, 0x400000
    s_xor_b32 s73, s73, 0x400000
    s_waitcnt vmcnt(0)
    s_branch PH_chk
PO_retry:
    s_cmp_eq_u32 s33, 0
    s_cbranch_scc1 PO_ok
    s_sub_u32 s33, s33, 1
    s_cmp_eq_u32 s101, 2
    s_cbranch_scc0 PO_ok
    s_mov_b64 exec, s[94:95]
    s_cbranch_execz PO_s0
    buffer_load_dwordx4 v[100:103], v195, s[20:23], s70 offen offset:0 sc1
PO_s0:
    s_mov_b64 exec, s[96:97]
    s_cbranch_execz PO_s1
    buffer_load_dwordx4 v[108:111], v195, s[20:23], s70 offen offset:1024 sc1
PO_s1:
    s_mov_b64 exec, s[98:99]
    s_cbranch_execz PO_s2
    buffer_load_dwordx4 v[200:203], v191, s[20:23], s68 offen offset:0 sc1
PO_s2:
    s_mov_b64 exec, -1
    s_waitcnt vmcnt(0)
    s_branch PO_chk
K_COPYB:
    s_lshl_b32 s98, s39, 10
    s_add_u32 s98, s98, 0x8000
    s_lshl_b32 s99, s28, 1
    s_lshr_b32 s100, s30, 1
    s_add_u32 s99, s99, s100
    s_lshl_b32 s99, s99, 3
    s_add_u32 s99, s99, s31
    s_lshl_b32 s99, s99, 10
    s_add_u32 s99, s99, 0x88000
    buffer_load_dwordx4 v[116:119], v195, s[20:23], s98 offen sc1
    buffer_load_dwordx4 v[124:127], v195, s[20:23], s99 offen sc1
    s_add_u32 s98, s98, 0x400000
    s_add_u32 s99, s99, 0x400000
    s_waitcnt vmcnt(0)
    buffer_store_dwordx4 v[116:119], v195, s[20:23], s98 offen sc1
    s_and_b32 s100, s30, 1
    s_lshl_b32 s100, s100, 1
    s_lshl_b32 exec_lo, 0x33333333, s100
    s_mov_b32 exec_hi, exec_lo
    buffer_store_dwordx4 v[124:127], v195, s[20:23], s99 offen sc1
    s_mov_b64 exec, -1
    s_waitcnt vmcnt(0)
    s_cmp_eq_u32 s98, 0
    s_branch K_COPYB_ret
K_COPYB2:
    s_lshl_b32 s98, s39, 10
    s_add_u32 s98, s98, 0x8000
    s_lshl_b32 s99, s28, 1
    s_lshr_b32 s100, s30, 1
    s_add_u32 s99, s99, s100
    s_lshl_b32 s99, s99, 3
    s_add_u32 s99, s99, s31
    s_lshl_b32 s99, s99, 10
    s_add_u32 s99, s99, 0x88000
    buffer_load_dwordx4 v[116:119], v195, s[20:23], s98 offen sc1
    buffer_load_dwordx4 v[124:127], v195, s[20:23], s99 offen sc1
    s_add_u32 s98, s98, 0x400000
    s_add_u32 s99, s99, 0x400000
    s_waitcnt vmcnt(0)
    buffer_store_dwordx4 v[116:119], v195, s[20:23], s98 offen sc1
    s_and_b32 s100, s30, 1
    s_lshl_b32 s100, s100, 1
    s_lshl_b32 exec_lo, 0x33333333, s100
    s_mov_b32 exec_hi, exec_lo
    buffer_store_dwordx4 v[124:127], v195, s[20:23], s99 offen sc1
    s_mov_b64 exec, -1
    s_branch K_COPYB2_ret
K_REMOTE:
    buffer_load_dwordx4 v[100:103], v195, s[20:23], s69 offen offset:0 sc1
    buffer_load_dwordx4 v[104:107], v195, s[20:23], s69 offen offset:1024 sc1
    buffer_load_dwordx4 v[108:111], v195, s[20:23], s69 offen offset:2048 sc1
    buffer_load_dwordx4 v[112:115], v195, s[20:23], s69 offen offset:3072 sc1
    buffer_load_dwordx4 v[200:203], v191, s[20:23], s68 offen sc1
    s_waitcnt vmcnt(0)
    v_cmpx_eq_u32 vcc, s32, v101
    v_cmpx_eq_u32 vcc, s32, v103
    v_cmpx_eq_u32 vcc, s32, v105
    v_cmpx_eq_u32 vcc, s32, v107
    v_cmpx_eq_u32 vcc, s32, v109
    v_cmpx_eq_u32 vcc, s32, v111
    v_cmpx_eq_u32 vcc, s32, v113
    v_cmpx_eq_u32 vcc, s32, v115
    v_cmpx_eq_u32 vcc, s32, v201
    v_cmpx_eq_u32 vcc, s32, v203
    s_cmp_eq_u64 exec, -1
    s_mov_b64 exec, -1
    s_cbranch_scc1 K_REMOTE_ok
    s_cmp_eq_u32 s33, 0
    s_cbranch_scc1 K_REMOTE_ok
    s_sub_u32 s33, s33, 1
    s_sleep 4
    s_branch K_REMOTE
K_REMOTE_ok:
    v_pk_mov_b32 v[100:101], v[100:101], v[102:103] op_sel:[0,0]
    v_pk_mov_b32 v[102:103], v[104:105], v[106:107] op_sel:[0,0]
    v_pk_mov_b32 v[108:109], v[108:109], v[110:111] op_sel:[0,0]
    v_pk_mov_b32 v[110:111], v[112:113], v[114:115] op_sel:[0,0]
    s_branch K_WF
V_REMOTE:
    s_add_u32 s95, s95, 0x130000
    s_lshl_b32 s96, s96, 1
    s_add_u32 s96, s96, s97
    s_add_u32 s96, s96, 0x200000
    v_lshlrev_b32 v7, 1, v10
    v_lshl_add_u32 v7, v5, 8, v7
    v_bfe_u32 v9, v0, 3, 1
    v_lshl_add_u32 v7, v9, 10, v7
    v_mov_b32 v209, s32
    v_mov_b32 v211, s32
    s_mov_b64 exec, s[92:93]
    buffer_store_dwordx4 v[200:203], v6, s[20:23], s95 offen sc1
    s_mov_b64 exec, -1
    s_nop 7
    v_add_f32_dpp v204, v145, v144 row_ror:8 row_mask:0xf bank_mask:0x3
    v_add_f32_dpp v205, v149, v148 row_ror:8 row_mask:0xf bank_mask:0x3
    v_add_f32_dpp v206, v153, v152 row_ror:8 row_mask:0xf bank_mask:0x3
    v_add_f32_dpp v207, v157, v156 row_ror:8 row_mask:0xf bank_mask:0x3
    v_add_f32_dpp v204, v160, v161 row_ror:8 row_mask:0xf bank_mask:0xc
    v_add_f32_dpp v205, v164, v165 row_ror:8 row_mask:0xf bank_mask:0xc
    v_add_f32_dpp v206, v168, v169 row_ror:8 row_mask:0xf bank_mask:0xc
    v_add_f32_dpp v207, v172, v173 row_ror:8 row_mask:0xf bank_mask:0xc
    v_cvt_pk_bf16_f32 v208, v204, v205
    v_cvt_pk_bf16_f32 v210, v206, v207
    s_mov_b32 exec_hi, 0
    buffer_store_dwordx4 v[208:211], v7, s[20:23], s96 offen sc1
    s_branch V_PUB
.fill 2600, 4, 0xbf810000
.section .rodata,"a"
.p2align 6
.amdhsa_kernel parallel_sum__sliding_block_cached__dense_activation_mish__decode_kernel
  .amdhsa_next_free_vgpr 216
  .amdhsa_next_free_sgpr 102
  .amdhsa_accum_offset 216
  .amdhsa_group_segment_fixed_size 0
  .amdhsa_kernarg_size 96
  .amdhsa_user_sgpr_count 2
  .amdhsa_user_sgpr_kernarg_segment_ptr 1
  .amdhsa_system_sgpr_workgroup_id_x 1
.end_amdhsa_kernel
```
